```python
import torch

def _softmax(x, axis=-1):
    return torch.softmax(x, dim=axis)
def _gelu(x):
    return torch.nn.functional.gelu(x, approximate="tanh")
def _silu(x):
    return torch.nn.functional.silu(x)
def _sigmoid(x):
    return torch.sigmoid(x)
def _layernorm(x, axis=-1, eps=1e-5):
    m = x.mean(dim=axis, keepdim=True)
    v = x.var(dim=axis, keepdim=True, unbiased=False)
    return (x - m) / torch.sqrt(v + eps)
def _scatter_add(tgt, idx, src, axis=0):
    return tgt.clone().index_add_(axis, idx, src)
def _segment_sum(src, seg, n):
    out = torch.zeros((n,) + src.shape[1:], dtype=src.dtype)
    return out.index_add_(0, seg, src)
def _pad(x, pw):
    flat = tuple(v for pair in reversed(pw) for v in pair)
    return torch.nn.functional.pad(x, flat)

kernel_name = 'sequential_preLN__gqa_block_cached__mixer_token_mlp__decode'

def setup_inputs():

    _w = (lambda a: (lambda t: t.to(torch.bfloat16) if t.is_floating_point() else t)(torch.as_tensor(a)))
    def _A_setup():
        B, Sq, D = 8, 1, 448
        Hq, Hkv, Sk, Dh = 16, 8, 8192, 256
        assert Hq % Hkv == 0, (Hq, Hkv)
        return {
            "x": _w((lambda *s: torch.randn(*s, dtype=torch.bfloat16) * 0.05)(B, Sq, D)),
            "k_cache": _w((lambda *s: torch.randn(*s, dtype=torch.bfloat16) * 1.6)(B, Hkv, Sk, Dh)),
            "v_cache": _w((lambda *s: torch.randn(*s, dtype=torch.bfloat16) * 0.8)(B, Hkv, Sk, Dh)),
            "wq": _w((lambda *s: torch.randn(*s, dtype=torch.bfloat16) * 1.6)(D, Hq * Dh) * (D ** -0.5)),
            "wo": _w((lambda *s: torch.randn(*s, dtype=torch.bfloat16) * 0.8)(Hq * Dh, D) * ((Hq * Dh) ** -0.5)),
        }
    _A_in = _A_setup()

    def _B_setup():
        B, S, D, F = 8, 1, 448, 1792
        return {
            "x": _w((lambda *s: torch.randn(*s, dtype=torch.bfloat16) * 0.05)(B, S, D)),
            "w1": _w((lambda *s: torch.randn(*s, dtype=torch.bfloat16) * 0.4)(S, F) * (S ** -0.5)),
            "b1": _w((lambda *s: torch.randn(*s, dtype=torch.bfloat16) * 0.4)(F) * 0.02),
            "w2": _w((lambda *s: torch.randn(*s, dtype=torch.bfloat16) * 0.4)(F, S) * (F ** -0.5)),
            "b2": _w((lambda *s: torch.randn(*s, dtype=torch.bfloat16) * 0.4)(S) * 0.02),
        }
    _B_in = _B_setup()

    return {
        "A_x": _A_in["x"],
        "A_k_cache": _A_in["k_cache"],
        "A_v_cache": _A_in["v_cache"],
        "A_wq": _A_in["wq"],
        "A_wo": _A_in["wo"],
        "B_x": _B_in["x"],
        "B_w1": _B_in["w1"],
        "B_b1": _B_in["b1"],
        "B_w2": _B_in["w2"],
        "B_b2": _B_in["b2"],
    }

def reference(A_x, A_k_cache, A_v_cache, A_wq, A_wo, B_x, B_w1, B_b1, B_w2, B_b2):
    def _A_ref(x, k_cache, v_cache, wq, wo):
        B, Sq, D = x.shape
        Hq, Dh = 16, 256
        Hkv = k_cache.shape[1]
        rep = Hq // Hkv
        q = (lambda x, *d: x.permute(*d))((x @ wq).reshape(B, Sq, Hq, Dh), 0, 2, 1, 3)
        k = (lambda x, n, axis: torch.repeat_interleave(x, n, dim=axis))(k_cache, rep, axis=1)
        v = (lambda x, n, axis: torch.repeat_interleave(x, n, dim=axis))(v_cache, rep, axis=1)
        scores = torch.einsum("bhqd,bhkd->bhqk", q, k) * (Dh ** -0.5)
        p = _softmax(scores, axis=-1)
        o = torch.einsum("bhqk,bhkd->bhqd", p, v)
        return (lambda x, *d: x.permute(*d))(o, 0, 2, 1, 3).reshape(B, Sq, Hq * Dh) @ wo

    def _B_ref(x, w1, b1, w2, b2):
        B, S, D = x.shape
        h = _layernorm(x, axis=-1)
        u = torch.einsum("bsd,sf->bdf", h, w1) + b1
        u = _gelu(u)
        y = torch.einsum("bdf,fs->bds", u, w2) + b2
        return (lambda x, *d: x.permute(*d))(y, 0, 2, 1)

    x = A_x
    h = x + _A_ref(_layernorm(x, axis=-1), A_k_cache, A_v_cache, A_wq, A_wo)
    h2 = h + _B_ref(_layernorm(h, axis=-1), B_w1, B_b1, B_w2, B_b2)
    return h2
```

```asm
; @launch grid=(256,1,1) block=(512,1,1) lds=145376
.amdgcn_target "amdgcn-amd-amdhsa--gfx950"
.text
.globl sequential_preLN__gqa_block_cached__mixer_token_mlp__decode_kernel
.p2align 8
.type sequential_preLN__gqa_block_cached__mixer_token_mlp__decode_kernel,@function
sequential_preLN__gqa_block_cached__mixer_token_mlp__decode_kernel:
s_cmp_ge_u32 s2, 256
s_cbranch_scc1 L_END
s_load_dwordx8 s[4:11], s[0:1], 0
s_load_dwordx2 s[12:13], s[0:1], 32
s_load_dwordx8 s[16:23], s[0:1], 48
s_load_dwordx4 s[24:27], s[0:1], 80
s_load_dwordx2 s[28:29], s[0:1], 96
s_memrealtime s[74:75]
v_lshrrev_b32 v31, 6, v0
v_and_b32 v1, 63, v0
v_readfirstlane_b32 s3, v31
s_lshr_b32 s63, s2, 2
s_and_b32 s62, s2, 3
s_and_b32 s60, s63, 7
s_lshr_b32 s61, s63, 3
s_mov_b32 s66, 0x05040100
s_mov_b32 s67, 0x07060302
s_mov_b32 s68, 0x3db8aa3b
s_lshl_b32 s15, s63, 22
s_lshl_b32 s69, s62, 17
s_add_u32 s64, s15, s69
s_lshl_b32 s69, s3, 14
s_add_u32 s64, s64, s69
v_and_b32 v27, 15, v1
v_lshrrev_b32 v28, 4, v1
v_lshrrev_b32 v29, 2, v27
v_lshlrev_b32 v25, 12, v29
v_lshl_add_u32 v25, v28, 6, v25
v_and_b32 v29, 3, v27
v_lshl_add_u32 v25, v29, 4, v25
v_lshlrev_b32 v26, 12, v28
v_lshl_add_u32 v26, v27, 4, v26
v_lshlrev_b32 v30, 4, v28
s_waitcnt lgkmcnt(0)
s_mov_b32 s32, s6
s_and_b32 s33, s7, 0xffff
s_mov_b32 s34, 268435456
s_mov_b32 s35, 0x00020000
s_mov_b32 s36, s8
s_and_b32 s37, s9, 0xffff
s_mov_b32 s38, 268435456
s_mov_b32 s39, 0x00020000
s_mov_b32 s40, s4
s_and_b32 s41, s5, 0xffff
s_mov_b32 s42, 7168
s_mov_b32 s43, 0x00020000
s_mov_b32 s44, s10
s_and_b32 s45, s11, 0xffff
s_mov_b32 s46, 3670016
s_mov_b32 s47, 0x00020000
s_mov_b32 s48, s26
s_and_b32 s49, s27, 0xffff
s_mov_b32 s50, 256
s_mov_b32 s51, 0x00020000
s_mul_i32 s69, s3, 896
v_lshlrev_b32 v29, 1, v1
buffer_load_ushort v10, v29, s[40:43], s69 offen offset:0
buffer_load_ushort v11, v29, s[40:43], s69 offen offset:128
buffer_load_ushort v12, v29, s[40:43], s69 offen offset:256
buffer_load_ushort v13, v29, s[40:43], s69 offen offset:384
buffer_load_ushort v14, v29, s[40:43], s69 offen offset:512
buffer_load_ushort v15, v29, s[40:43], s69 offen offset:640
buffer_load_ushort v16, v29, s[40:43], s69 offen offset:768
s_lshl_b32 s70, s62, 3
s_add_u32 s77, s70, s61
s_cmp_eq_u32 s3, 7
s_cbranch_scc1 L_NONCE
v_lshrrev_b32 v31, 3, v1
v_lshlrev_b32 v31, 16, v31
v_and_b32 v29, 7, v1
v_lshl_add_u32 v31, v29, 2, v31
s_lshl_b32 s70, s77, 5
s_lshl_b32 s71, s60, 10
s_add_u32 s70, s70, s71
s_lshl_b32 s71, s3, 19
s_add_u32 s71, s71, s70
buffer_load_dword v160, v31, s[44:47], s71 offen
s_add_u32 s71, s71, 8192
buffer_load_dword v161, v31, s[44:47], s71 offen
s_add_u32 s71, s71, 8192
buffer_load_dword v162, v31, s[44:47], s71 offen
s_add_u32 s71, s71, 8192
buffer_load_dword v163, v31, s[44:47], s71 offen
s_add_u32 s71, s71, 8192
buffer_load_dword v164, v31, s[44:47], s71 offen
s_add_u32 s71, s71, 8192
buffer_load_dword v165, v31, s[44:47], s71 offen
s_add_u32 s71, s71, 8192
buffer_load_dword v166, v31, s[44:47], s71 offen
s_add_u32 s71, s71, 8192
buffer_load_dword v167, v31, s[44:47], s71 offen
s_add_u32 s71, s71, 8192
s_waitcnt vmcnt(8)
s_branch L_LN
L_NONCE:
s_or_b32 s74, s74, 1
v_mov_b32 v160, s74
v_mov_b32 v161, s75
v_mov_b32 v162, 0
v_mov_b32 v163, 0
v_mov_b32 v164, 0
s_cmp_ge_u32 s2, 8
s_cbranch_scc1 L_NOCAS
s_mov_b64 exec, 1
buffer_atomic_cmpswap_x2 v[160:163], v164, s[48:51], 0 offen
s_mov_b64 exec, -1
s_waitcnt vmcnt(1)
s_branch L_LN
L_NOCAS:
s_waitcnt vmcnt(0)
L_LN:
v_lshlrev_b32 v10, 16, v10
v_lshlrev_b32 v11, 16, v11
v_lshlrev_b32 v12, 16, v12
v_lshlrev_b32 v13, 16, v13
v_lshlrev_b32 v14, 16, v14
v_lshlrev_b32 v15, 16, v15
v_lshlrev_b32 v16, 16, v16
v_add_f32 v2, v10, v11
v_add_f32 v2, v2, v12
v_add_f32 v2, v2, v13
v_add_f32 v2, v2, v14
v_add_f32 v2, v2, v15
v_add_f32 v2, v2, v16
s_nop 1
v_add_f32_dpp v2, v2, v2 quad_perm:[1,0,3,2] row_mask:0xf bank_mask:0xf
s_nop 1
v_add_f32_dpp v2, v2, v2 quad_perm:[2,3,0,1] row_mask:0xf bank_mask:0xf
s_nop 1
v_add_f32_dpp v2, v2, v2 row_half_mirror row_mask:0xf bank_mask:0xf
s_nop 1
v_add_f32_dpp v2, v2, v2 row_mirror row_mask:0xf bank_mask:0xf
v_mov_b32 v3, v2
v_mov_b32 v4, v2
s_nop 1
v_permlane16_swap_b32 v3, v4
s_nop 1
v_add_f32 v2, v3, v4
v_mov_b32 v3, v2
v_mov_b32 v4, v2
s_nop 1
v_permlane32_swap_b32 v3, v4
s_nop 1
v_add_f32 v2, v3, v4
v_mul_f32 v5, 0x3b124925, v2
v_sub_f32 v6, v10, v5
v_mul_f32 v2, v6, v6
v_sub_f32 v6, v11, v5
v_fmac_f32 v2, v6, v6
v_sub_f32 v6, v12, v5
v_fmac_f32 v2, v6, v6
v_sub_f32 v6, v13, v5
v_fmac_f32 v2, v6, v6
v_sub_f32 v6, v14, v5
v_fmac_f32 v2, v6, v6
v_sub_f32 v6, v15, v5
v_fmac_f32 v2, v6, v6
v_sub_f32 v6, v16, v5
v_fmac_f32 v2, v6, v6
s_nop 1
v_add_f32_dpp v2, v2, v2 quad_perm:[1,0,3,2] row_mask:0xf bank_mask:0xf
s_nop 1
v_add_f32_dpp v2, v2, v2 quad_perm:[2,3,0,1] row_mask:0xf bank_mask:0xf
s_nop 1
v_add_f32_dpp v2, v2, v2 row_half_mirror row_mask:0xf bank_mask:0xf
s_nop 1
v_add_f32_dpp v2, v2, v2 row_mirror row_mask:0xf bank_mask:0xf
v_mov_b32 v3, v2
v_mov_b32 v4, v2
s_nop 1
v_permlane16_swap_b32 v3, v4
s_nop 1
v_add_f32 v2, v3, v4
v_mov_b32 v3, v2
v_mov_b32 v4, v2
s_nop 1
v_permlane32_swap_b32 v3, v4
s_nop 1
v_add_f32 v2, v3, v4
v_mul_f32 v2, 0x3b124925, v2
v_cvt_pk_bf16_f32 v3, v5, v2
v_lshlrev_b32 v5, 16, v3
v_and_b32 v2, 0xffff0000, v3
v_add_f32 v2, 0x3727c5ac, v2
v_cvt_pk_bf16_f32 v3, v2, v2
v_lshlrev_b32 v2, 16, v3
v_sqrt_f32 v2, v2
s_nop 0
v_cvt_pk_bf16_f32 v3, v2, v2
v_lshlrev_b32 v2, 16, v3
v_rcp_f32 v7, v2
s_nop 0
v_sub_f32 v10, v10, v5
v_sub_f32 v11, v11, v5
v_sub_f32 v12, v12, v5
v_sub_f32 v13, v13, v5
v_sub_f32 v14, v14, v5
v_sub_f32 v15, v15, v5
v_sub_f32 v16, v16, v5
v_cvt_pk_bf16_f32 v3, v10, v11
v_lshlrev_b32 v10, 16, v3
v_and_b32 v11, 0xffff0000, v3
v_cvt_pk_bf16_f32 v3, v12, v13
v_lshlrev_b32 v12, 16, v3
v_and_b32 v13, 0xffff0000, v3
v_cvt_pk_bf16_f32 v3, v14, v15
v_lshlrev_b32 v14, 16, v3
v_and_b32 v15, 0xffff0000, v3
v_cvt_pk_bf16_f32 v3, v16, v16
v_lshlrev_b32 v16, 16, v3
v_mul_f32 v10, v10, v7
v_mul_f32 v11, v11, v7
v_mul_f32 v12, v12, v7
v_mul_f32 v13, v13, v7
v_mul_f32 v14, v14, v7
v_mul_f32 v15, v15, v7
v_mul_f32 v16, v16, v7
v_cvt_pk_bf16_f32 v3, v10, v11
v_lshlrev_b32 v10, 16, v3
v_and_b32 v11, 0xffff0000, v3
v_cvt_pk_bf16_f32 v3, v12, v13
v_lshlrev_b32 v12, 16, v3
v_and_b32 v13, 0xffff0000, v3
v_cvt_pk_bf16_f32 v3, v14, v15
v_lshlrev_b32 v14, 16, v3
v_and_b32 v15, 0xffff0000, v3
v_cvt_pk_bf16_f32 v3, v16, v16
v_lshlrev_b32 v16, 16, v3
v_lshlrev_b32 v29, 1, v1
s_add_u32 s69, s69, 114688
v_add_u32 v29, s69, v29
v_lshrrev_b32 v10, 16, v10
ds_write_b16 v29, v10 offset:0
v_lshrrev_b32 v11, 16, v11
ds_write_b16 v29, v11 offset:128
v_lshrrev_b32 v12, 16, v12
ds_write_b16 v29, v12 offset:256
v_lshrrev_b32 v13, 16, v13
ds_write_b16 v29, v13 offset:384
v_lshrrev_b32 v14, 16, v14
ds_write_b16 v29, v14 offset:512
v_lshrrev_b32 v15, 16, v15
ds_write_b16 v29, v15 offset:640
v_lshrrev_b32 v16, 16, v16
ds_write_b16 v29, v16 offset:768
v_and_b32 v29, 7, v1
v_mul_u32_u24 v29, 896, v29
v_lshrrev_b32 v31, 3, v1
v_lshl_add_u32 v29, v31, 4, v29
s_lshl_b32 s69, s3, 7
s_add_u32 s69, s69, 114688
v_add_u32 v29, s69, v29
s_waitcnt lgkmcnt(0)
s_barrier
s_cmp_eq_u32 s3, 7
s_cbranch_scc1 L_NONCE2
ds_read_b128 v[2:5], v29
s_waitcnt vmcnt(0)
v_perm_b32 v168, v161, v160, s66
v_perm_b32 v172, v161, v160, s67
v_perm_b32 v169, v163, v162, s66
v_perm_b32 v173, v163, v162, s67
v_perm_b32 v170, v165, v164, s66
v_perm_b32 v174, v165, v164, s67
v_perm_b32 v171, v167, v166, s66
v_perm_b32 v175, v167, v166, s67
v_lshrrev_b32 v29, 4, v1
v_lshlrev_b32 v29, 8, v29
v_and_b32 v31, 7, v1
v_lshl_add_u32 v29, v31, 3, v29
s_lshl_b32 s69, s3, 10
s_add_u32 s69, s69, 122880
v_add_u32 v29, s69, v29
v_lshrrev_b32 v31, 5, v1
v_bfe_u32 v6, v1, 3, 1
v_cmp_eq_u32 vcc, v31, v6
s_waitcnt lgkmcnt(0)
v_mfma_f32_16x16x32_bf16 v[176:179], v[2:5], v[168:171], 0
v_mfma_f32_16x16x32_bf16 v[180:183], v[2:5], v[172:175], 0
s_and_saveexec_b64 s[72:73], vcc
s_nop 7
v_mov_b32 v6, v176
v_mov_b32 v7, v180
ds_write_b64 v29, v[6:7] offset:0
v_mov_b32 v6, v177
v_mov_b32 v7, v181
ds_write_b64 v29, v[6:7] offset:64
v_mov_b32 v6, v178
v_mov_b32 v7, v182
ds_write_b64 v29, v[6:7] offset:128
v_mov_b32 v6, v179
v_mov_b32 v7, v183
ds_write_b64 v29, v[6:7] offset:192
s_mov_b64 exec, s[72:73]
s_branch L_QRED
L_NONCE2:
buffer_load_dwordx2 v[2:3], v164, s[48:51], 0 offen sc1
s_waitcnt vmcnt(0)
v_readfirstlane_b32 s70, v2
v_readfirstlane_b32 s71, v3
s_cmp_eq_u64 s[70:71], 0
s_cbranch_scc1 L_NONCE2
v_mov_b32 v4, 145280
ds_write_b64 v4, v[2:3]
v_mov_b32 v5, 0
ds_write_b32 v4, v5 offset:80
L_QRED:
s_waitcnt lgkmcnt(0)
s_barrier
v_mov_b32 v4, 145280
ds_read_b64 v[2:3], v4
s_waitcnt lgkmcnt(0)
v_readfirstlane_b32 s78, v2
v_readfirstlane_b32 s79, v3
s_add_u32 s8, s28, 1507328
s_addc_u32 s9, s29, 0
s_and_b32 s9, s9, 0xffff
s_mov_b32 s10, 16384
s_mov_b32 s11, 0x00020000
s_lshl_b32 s14, s63, 8
s_cmp_lg_u32 s3, 0
s_cbranch_scc1 L_PACED
v_lshlrev_b32 v29, 3, v1
v_add_u32 v29, 122880, v29
ds_read_b64 v[32:33], v29 offset:0
ds_read_b64 v[34:35], v29 offset:512
ds_read_b64 v[36:37], v29 offset:1024
ds_read_b64 v[38:39], v29 offset:1536
ds_read_b64 v[40:41], v29 offset:2048
ds_read_b64 v[42:43], v29 offset:2560
ds_read_b64 v[44:45], v29 offset:3072
ds_read_b64 v[46:47], v29 offset:3584
ds_read_b64 v[48:49], v29 offset:4096
ds_read_b64 v[50:51], v29 offset:4608
ds_read_b64 v[52:53], v29 offset:5120
ds_read_b64 v[54:55], v29 offset:5632
ds_read_b64 v[56:57], v29 offset:6144
ds_read_b64 v[58:59], v29 offset:6656
s_mov_b32 s40, s28
s_and_b32 s41, s29, 0xffff
s_mov_b32 s42, 131072
s_mov_b32 s43, 0x00020000
v_lshrrev_b32 v29, 3, v1
v_lshlrev_b32 v29, 14, v29
v_and_b32 v31, 7, v1
v_lshl_add_u32 v29, v31, 3, v29
s_lshl_b32 s69, s60, 11
s_lshl_b32 s70, s77, 6
s_add_u32 s69, s69, s70
v_mov_b32 v14, s78
v_mov_b32 v15, s79
s_cmp_lg_u32 s62, 0
s_cbranch_scc1 L_NOINIT
s_add_u32 s44, s28, 1507328
s_addc_u32 s45, s29, 0
s_and_b32 s45, s45, 0xffff
s_mov_b32 s46, 16384
s_mov_b32 s47, 0x00020000
s_lshl_b32 s70, s63, 8
v_mov_b32 v12, 64
v_mov_b32 v13, 0
s_mov_b64 exec, 1
buffer_store_dword v12, v13, s[44:47], s70 offen sc1
s_mov_b64 exec, -1
s_waitcnt vmcnt(0)
L_NOINIT:
s_waitcnt lgkmcnt(0)
v_add_f32 v32, v32, v34
v_add_f32 v33, v33, v35
v_add_f32 v32, v32, v36
v_add_f32 v33, v33, v37
v_add_f32 v32, v32, v38
v_add_f32 v33, v33, v39
v_add_f32 v32, v32, v40
v_add_f32 v33, v33, v41
v_add_f32 v32, v32, v42
v_add_f32 v33, v33, v43
v_add_f32 v32, v32, v44
v_add_f32 v33, v33, v45
v_add_f32 v32, v32, v46
v_add_f32 v33, v33, v47
v_add_f32 v32, v32, v48
v_add_f32 v33, v33, v49
v_add_f32 v32, v32, v50
v_add_f32 v33, v33, v51
v_add_f32 v32, v32, v52
v_add_f32 v33, v33, v53
v_add_f32 v32, v32, v54
v_add_f32 v33, v33, v55
v_add_f32 v32, v32, v56
v_add_f32 v33, v33, v57
v_add_f32 v32, v32, v58
v_add_f32 v33, v33, v59
v_cvt_pk_bf16_f32 v12, v32, v33
s_nop 1
v_mov_b32_dpp v13, v12 quad_perm:[1,0,3,2] row_mask:0xf bank_mask:0xf
s_mov_b32 exec_lo, 0x55555555
s_mov_b32 exec_hi, 0x55555555
buffer_store_dwordx4 v[12:15], v29, s[40:43], s69 offen sc1
s_mov_b64 exec, -1
v_lshlrev_b32 v29, 4, v1
s_lshl_b32 s69, s63, 11
L_H0_RETRY:
buffer_load_dwordx4 v[32:35], v29, s[40:43], s69 offen sc1
buffer_load_dwordx4 v[36:39], v29, s[40:43], s69 offen offset:1024 sc1
s_waitcnt vmcnt(0)
s_mov_b64 s[72:73], exec
v_cmp_eq_u64 vcc, s[78:79], v[34:35]
s_and_b64 s[72:73], s[72:73], vcc
v_cmp_eq_u64 vcc, s[78:79], v[38:39]
s_and_b64 s[72:73], s[72:73], vcc
s_cmp_eq_u64 s[72:73], exec
s_cbranch_scc1 L_H0_OK
s_sleep 2
s_branch L_H0_RETRY
L_H0_OK:
v_lshlrev_b32 v29, 3, v1
v_add_u32 v29, 121856, v29
ds_write_b64 v29, v[32:33]
ds_write_b64 v29, v[36:37] offset:512
v_mov_b32 v5, 1
v_mov_b32 v4, 145360
ds_write_b32 v4, v5
buffer_load_dwordx4 v[32:35], v25, s[32:35], s64 offen offset:0 nt
buffer_load_dwordx4 v[36:39], v25, s[32:35], s64 offen offset:256 nt
buffer_load_dwordx4 v[40:43], v25, s[32:35], s64 offen offset:512 nt
buffer_load_dwordx4 v[44:47], v25, s[32:35], s64 offen offset:768 nt
buffer_load_dwordx4 v[48:51], v25, s[32:35], s64 offen offset:1024 nt
buffer_load_dwordx4 v[52:55], v25, s[32:35], s64 offen offset:1280 nt
buffer_load_dwordx4 v[56:59], v25, s[32:35], s64 offen offset:1536 nt
buffer_load_dwordx4 v[60:63], v25, s[32:35], s64 offen offset:1792 nt
buffer_load_dwordx4 v[64:67], v25, s[32:35], s64 offen offset:2048 nt
buffer_load_dwordx4 v[68:71], v25, s[32:35], s64 offen offset:2304 nt
buffer_load_dwordx4 v[72:75], v25, s[32:35], s64 offen offset:2560 nt
buffer_load_dwordx4 v[76:79], v25, s[32:35], s64 offen offset:2816 nt
buffer_load_dwordx4 v[80:83], v25, s[32:35], s64 offen offset:3072 nt
buffer_load_dwordx4 v[84:87], v25, s[32:35], s64 offen offset:3328 nt
buffer_load_dwordx4 v[88:91], v25, s[32:35], s64 offen offset:3584 nt
buffer_load_dwordx4 v[92:95], v25, s[32:35], s64 offen offset:3840 nt
s_lshl_b32 s69, s62, 3
s_add_u32 s69, s69, s3
s_add_u32 s69, s69, 32
v_mov_b32 v31, s69
s_mov_b64 exec, 1
buffer_load_dword v21, v1, s[32:35], s64 offen
s_mov_b64 exec, -1
buffer_load_dwordx4 v[96:99], v26, s[36:39], s64 offen offset:0 nt
buffer_load_dwordx4 v[100:103], v26, s[36:39], s64 offen offset:512 nt
buffer_load_dwordx4 v[104:107], v26, s[36:39], s64 offen offset:1024 nt
buffer_load_dwordx4 v[108:111], v26, s[36:39], s64 offen offset:1536 nt
buffer_load_dwordx4 v[112:115], v26, s[36:39], s64 offen offset:2048 nt
buffer_load_dwordx4 v[116:119], v26, s[36:39], s64 offen offset:2560 nt
buffer_load_dwordx4 v[120:123], v26, s[36:39], s64 offen offset:3072 nt
buffer_load_dwordx4 v[124:127], v26, s[36:39], s64 offen offset:3584 nt
buffer_load_dwordx4 v[128:131], v26, s[36:39], s64 offen offset:256 nt
buffer_load_dwordx4 v[132:135], v26, s[36:39], s64 offen offset:768 nt
buffer_load_dwordx4 v[136:139], v26, s[36:39], s64 offen offset:1280 nt
buffer_load_dwordx4 v[140:143], v26, s[36:39], s64 offen offset:1792 nt
buffer_load_dwordx4 v[144:147], v26, s[36:39], s64 offen offset:2304 nt
buffer_load_dwordx4 v[148:151], v26, s[36:39], s64 offen offset:2816 nt
buffer_load_dwordx4 v[152:155], v26, s[36:39], s64 offen offset:3328 nt
buffer_load_dwordx4 v[156:159], v26, s[36:39], s64 offen offset:3840 nt
s_waitcnt lgkmcnt(0)
s_branch L_JOIN
L_PACED:
v_mov_b32 v4, 145360
buffer_load_dwordx4 v[32:35], v25, s[32:35], s64 offen offset:0 nt
buffer_load_dwordx4 v[36:39], v25, s[32:35], s64 offen offset:256 nt
buffer_load_dwordx4 v[40:43], v25, s[32:35], s64 offen offset:512 nt
buffer_load_dwordx4 v[44:47], v25, s[32:35], s64 offen offset:768 nt
buffer_load_dwordx4 v[48:51], v25, s[32:35], s64 offen offset:1024 nt
buffer_load_dwordx4 v[52:55], v25, s[32:35], s64 offen offset:1280 nt
buffer_load_dwordx4 v[56:59], v25, s[32:35], s64 offen offset:1536 nt
buffer_load_dwordx4 v[60:63], v25, s[32:35], s64 offen offset:1792 nt
ds_read_b32 v5, v4
s_waitcnt lgkmcnt(0)
v_readfirstlane_b32 s69, v5
s_cmp_lg_u32 s69, 0
s_cbranch_scc1 L_PSK0
s_waitcnt vmcnt(8)
L_PSK0:
buffer_load_dwordx4 v[64:67], v25, s[32:35], s64 offen offset:2048 nt
buffer_load_dwordx4 v[68:71], v25, s[32:35], s64 offen offset:2304 nt
buffer_load_dwordx4 v[72:75], v25, s[32:35], s64 offen offset:2560 nt
buffer_load_dwordx4 v[76:79], v25, s[32:35], s64 offen offset:2816 nt
buffer_load_dwordx4 v[80:83], v25, s[32:35], s64 offen offset:3072 nt
buffer_load_dwordx4 v[84:87], v25, s[32:35], s64 offen offset:3328 nt
buffer_load_dwordx4 v[88:91], v25, s[32:35], s64 offen offset:3584 nt
buffer_load_dwordx4 v[92:95], v25, s[32:35], s64 offen offset:3840 nt
ds_read_b32 v5, v4
s_waitcnt lgkmcnt(0)
v_readfirstlane_b32 s69, v5
s_cmp_lg_u32 s69, 0
s_cbranch_scc1 L_PSK1
s_waitcnt vmcnt(8)
L_PSK1:
s_lshl_b32 s69, s62, 3
s_add_u32 s69, s69, s3
s_add_u32 s69, s69, 32
v_mov_b32 v31, s69
s_mov_b64 exec, 1
buffer_load_dword v21, v1, s[32:35], s64 offen
s_mov_b64 exec, -1
buffer_load_dwordx4 v[96:99], v26, s[36:39], s64 offen offset:0 nt
buffer_load_dwordx4 v[100:103], v26, s[36:39], s64 offen offset:512 nt
buffer_load_dwordx4 v[104:107], v26, s[36:39], s64 offen offset:1024 nt
buffer_load_dwordx4 v[108:111], v26, s[36:39], s64 offen offset:1536 nt
buffer_load_dwordx4 v[112:115], v26, s[36:39], s64 offen offset:2048 nt
buffer_load_dwordx4 v[116:119], v26, s[36:39], s64 offen offset:2560 nt
buffer_load_dwordx4 v[120:123], v26, s[36:39], s64 offen offset:3072 nt
buffer_load_dwordx4 v[124:127], v26, s[36:39], s64 offen offset:3584 nt
ds_read_b32 v5, v4
s_waitcnt lgkmcnt(0)
v_readfirstlane_b32 s69, v5
s_cmp_lg_u32 s69, 0
s_cbranch_scc1 L_PSK2
s_waitcnt vmcnt(8)
L_PSK2:
buffer_load_dwordx4 v[128:131], v26, s[36:39], s64 offen offset:256 nt
buffer_load_dwordx4 v[132:135], v26, s[36:39], s64 offen offset:768 nt
buffer_load_dwordx4 v[136:139], v26, s[36:39], s64 offen offset:1280 nt
buffer_load_dwordx4 v[140:143], v26, s[36:39], s64 offen offset:1792 nt
buffer_load_dwordx4 v[144:147], v26, s[36:39], s64 offen offset:2304 nt
buffer_load_dwordx4 v[148:151], v26, s[36:39], s64 offen offset:2816 nt
buffer_load_dwordx4 v[152:155], v26, s[36:39], s64 offen offset:3328 nt
buffer_load_dwordx4 v[156:159], v26, s[36:39], s64 offen offset:3840 nt
L_JOIN:
s_barrier
v_and_b32 v27, 15, v1
v_lshrrev_b32 v28, 4, v1
v_and_b32 v29, 7, v27
v_lshrrev_b32 v20, 2, v29
v_lshlrev_b32 v20, 9, v20
v_lshl_add_u32 v20, v28, 6, v20
v_and_b32 v29, 3, v27
v_lshl_add_u32 v20, v29, 4, v20
v_add_u32 v20, 121856, v20
ds_read_b128 v[2:5], v20
ds_read_b128 v[6:9], v20 offset:256
s_cmp_lt_u32 s3, 4
s_cbranch_scc1 L_NODMA
s_mov_b32 s40, s12
s_and_b32 s41, s13, 0xffff
s_mov_b32 s42, 3670016
s_mov_b32 s43, 0x00020000
v_mul_u32_u24 v29, 4682, v1
v_lshrrev_b32 v29, 16, v29
v_mul_u32_u24 v28, 672, v29
v_lshl_add_u32 v28, v1, 4, v28
s_sub_u32 s69, s3, 4
s_mul_i32 s70, s69, 28672
s_lshl_b32 s71, s60, 2
s_add_u32 s71, s71, s69
s_mul_i32 s71, s71, 114688
s_mul_i32 s72, s62, 224
s_add_u32 s71, s71, s72
s_mov_b32 s72, 0
s_mov_b32 exec_hi, 0x00ffffff
L_WODMA:
s_mov_b32 m0, s70
s_add_u32 s70, s70, 896
buffer_load_dwordx4 v28, s[40:43], s71 offen lds
s_add_u32 s71, s71, 3584
s_add_u32 s72, s72, 1
s_cmp_lt_u32 s72, 32
s_cbranch_scc1 L_WODMA
s_mov_b64 exec, -1
L_NODMA:
v_mov_b32 v192, 0
v_mov_b32 v193, 0
v_mov_b32 v194, 0
v_mov_b32 v195, 0
v_mov_b32 v196, 0
v_mov_b32 v197, 0
v_mov_b32 v198, 0
v_mov_b32 v199, 0
v_mov_b32 v200, 0
v_mov_b32 v201, 0
v_mov_b32 v202, 0
v_mov_b32 v203, 0
v_mov_b32 v204, 0
v_mov_b32 v205, 0
v_mov_b32 v206, 0
v_mov_b32 v207, 0
v_mov_b32 v208, 0
v_mov_b32 v209, 0
v_mov_b32 v210, 0
v_mov_b32 v211, 0
v_mov_b32 v212, 0
v_mov_b32 v213, 0
v_mov_b32 v214, 0
v_mov_b32 v215, 0
v_mov_b32 v216, 0
v_mov_b32 v217, 0
v_mov_b32 v218, 0
v_mov_b32 v219, 0
v_mov_b32 v220, 0
v_mov_b32 v221, 0
v_mov_b32 v222, 0
v_mov_b32 v223, 0
v_mov_b32 v224, 0
v_mov_b32 v225, 0
v_mov_b32 v226, 0
v_mov_b32 v227, 0
v_mov_b32 v228, 0
v_mov_b32 v229, 0
v_mov_b32 v230, 0
v_mov_b32 v231, 0
v_mov_b32 v232, 0
v_mov_b32 v233, 0
v_mov_b32 v234, 0
v_mov_b32 v235, 0
v_mov_b32 v236, 0
v_mov_b32 v237, 0
v_mov_b32 v238, 0
v_mov_b32 v239, 0
v_mov_b32 v240, 0
v_mov_b32 v241, 0
v_mov_b32 v242, 0
v_mov_b32 v243, 0
v_mov_b32 v244, 0
v_mov_b32 v245, 0
v_mov_b32 v246, 0
v_mov_b32 v247, 0
v_mov_b32 v248, 0
v_mov_b32 v249, 0
v_mov_b32 v250, 0
v_mov_b32 v251, 0
v_mov_b32 v252, 0
v_mov_b32 v253, 0
v_mov_b32 v254, 0
v_mov_b32 v255, 0
v_mov_b32 v22, 0xff7fffff
v_mov_b32 v23, 0
v_mov_b32 v24, 0
v_cmp_gt_u32 vcc, 8, v27
s_waitcnt lgkmcnt(0)
s_nop 0
v_cndmask_b32 v2, 0, v2, vcc
v_cndmask_b32 v3, 0, v3, vcc
v_cndmask_b32 v4, 0, v4, vcc
v_cndmask_b32 v5, 0, v5, vcc
v_cndmask_b32 v6, 0, v6, vcc
v_cndmask_b32 v7, 0, v7, vcc
v_cndmask_b32 v8, 0, v8, vcc
v_cndmask_b32 v9, 0, v9, vcc
s_mov_b32 s65, 0
s_mov_b32 s40, s16
s_and_b32 s41, s17, 0xffff
s_mov_b32 s42, 3584
s_mov_b32 s43, 0x00020000
s_mov_b32 s44, s18
s_and_b32 s45, s19, 0xffff
s_mov_b32 s46, 3584
s_mov_b32 s47, 0x00020000
s_mov_b32 s48, s20
s_and_b32 s49, s21, 0xffff
s_mov_b32 s50, 3584
s_mov_b32 s51, 0x00020000
s_mov_b32 s52, s22
s_and_b32 s53, s23, 0xffff
s_mov_b32 s54, 2
s_mov_b32 s55, 0x00020000
s_mov_b32 s56, s4
s_and_b32 s57, s5, 0xffff
s_mov_b32 s58, 7168
s_mov_b32 s59, 0x00020000
L_LOOP:
s_waitcnt vmcnt(17)
v_mfma_f32_16x16x32_bf16 v[160:163], v[32:35], v[2:5], 0
v_mfma_f32_16x16x32_bf16 v[164:167], v[40:43], v[2:5], 0
v_mfma_f32_16x16x32_bf16 v[168:171], v[48:51], v[2:5], 0
v_mfma_f32_16x16x32_bf16 v[172:175], v[56:59], v[2:5], 0
v_mfma_f32_16x16x32_bf16 v[176:179], v[64:67], v[2:5], 0
v_mfma_f32_16x16x32_bf16 v[180:183], v[72:75], v[2:5], 0
v_mfma_f32_16x16x32_bf16 v[184:187], v[80:83], v[2:5], 0
v_mfma_f32_16x16x32_bf16 v[188:191], v[88:91], v[2:5], 0
v_mfma_f32_16x16x32_bf16 v[160:163], v[36:39], v[6:9], v[160:163]
v_mfma_f32_16x16x32_bf16 v[164:167], v[44:47], v[6:9], v[164:167]
v_mfma_f32_16x16x32_bf16 v[168:171], v[52:55], v[6:9], v[168:171]
v_mfma_f32_16x16x32_bf16 v[172:175], v[60:63], v[6:9], v[172:175]
v_mfma_f32_16x16x32_bf16 v[176:179], v[68:71], v[6:9], v[176:179]
v_mfma_f32_16x16x32_bf16 v[180:183], v[76:79], v[6:9], v[180:183]
v_mfma_f32_16x16x32_bf16 v[184:187], v[84:87], v[6:9], v[184:187]
v_mfma_f32_16x16x32_bf16 v[188:191], v[92:95], v[6:9], v[188:191]
s_waitcnt vmcnt(16)
v_readfirstlane_b32 s69, v31
s_cmp_ge_u32 s69, 256
s_cbranch_scc1 L_LASTK
s_lshl_b32 s69, s69, 14
s_add_u32 s64, s15, s69
buffer_load_dwordx4 v[32:35], v25, s[32:35], s64 offen offset:0 nt
buffer_load_dwordx4 v[36:39], v25, s[32:35], s64 offen offset:256 nt
buffer_load_dwordx4 v[40:43], v25, s[32:35], s64 offen offset:512 nt
buffer_load_dwordx4 v[44:47], v25, s[32:35], s64 offen offset:768 nt
buffer_load_dwordx4 v[48:51], v25, s[32:35], s64 offen offset:1024 nt
buffer_load_dwordx4 v[52:55], v25, s[32:35], s64 offen offset:1280 nt
buffer_load_dwordx4 v[56:59], v25, s[32:35], s64 offen offset:1536 nt
buffer_load_dwordx4 v[60:63], v25, s[32:35], s64 offen offset:1792 nt
buffer_load_dwordx4 v[64:67], v25, s[32:35], s64 offen offset:2048 nt
buffer_load_dwordx4 v[68:71], v25, s[32:35], s64 offen offset:2304 nt
buffer_load_dwordx4 v[72:75], v25, s[32:35], s64 offen offset:2560 nt
buffer_load_dwordx4 v[76:79], v25, s[32:35], s64 offen offset:2816 nt
buffer_load_dwordx4 v[80:83], v25, s[32:35], s64 offen offset:3072 nt
buffer_load_dwordx4 v[84:87], v25, s[32:35], s64 offen offset:3328 nt
buffer_load_dwordx4 v[88:91], v25, s[32:35], s64 offen offset:3584 nt
buffer_load_dwordx4 v[92:95], v25, s[32:35], s64 offen offset:3840 nt
v_mov_b32 v31, 1
s_mov_b64 exec, 1
buffer_atomic_add v31, v1, s[8:11], s14 offen sc0
s_mov_b64 exec, -1
s_branch L_AFTK
L_LASTK:
s_mov_b32 s65, 1
v_mul_u32_u24 v27, 56, v1
buffer_load_dwordx2 v[32:33], v27, s[40:43], 0 offen offset:0
buffer_load_dwordx2 v[34:35], v27, s[40:43], 0 offen offset:8
buffer_load_dwordx2 v[36:37], v27, s[40:43], 0 offen offset:16
buffer_load_dwordx2 v[38:39], v27, s[40:43], 0 offen offset:24
buffer_load_dwordx2 v[40:41], v27, s[40:43], 0 offen offset:32
buffer_load_dwordx2 v[42:43], v27, s[40:43], 0 offen offset:40
buffer_load_dwordx2 v[44:45], v27, s[40:43], 0 offen offset:48
buffer_load_dwordx2 v[46:47], v27, s[44:47], 0 offen offset:0
buffer_load_dwordx2 v[48:49], v27, s[44:47], 0 offen offset:8
buffer_load_dwordx2 v[50:51], v27, s[44:47], 0 offen offset:16
buffer_load_dwordx2 v[52:53], v27, s[44:47], 0 offen offset:24
buffer_load_dwordx2 v[54:55], v27, s[44:47], 0 offen offset:32
buffer_load_dwordx2 v[56:57], v27, s[44:47], 0 offen offset:40
buffer_load_dwordx2 v[58:59], v27, s[44:47], 0 offen offset:48
buffer_load_dwordx2 v[60:61], v27, s[48:51], 0 offen offset:0
buffer_load_dwordx2 v[62:63], v27, s[48:51], 0 offen offset:8
buffer_load_dwordx2 v[64:65], v27, s[48:51], 0 offen offset:16
buffer_load_dwordx2 v[66:67], v27, s[48:51], 0 offen offset:24
buffer_load_dwordx2 v[68:69], v27, s[48:51], 0 offen offset:32
buffer_load_dwordx2 v[70:71], v27, s[48:51], 0 offen offset:40
buffer_load_dwordx2 v[72:73], v27, s[48:51], 0 offen offset:48
v_lshlrev_b32 v27, 1, v0
s_mul_i32 s69, s61, 896
buffer_load_ushort v74, v27, s[56:59], s69 offen
v_mov_b32 v27, 0
buffer_load_ushort v75, v27, s[52:55], 0 offen
L_AFTK:
v_mov_b32_dpp v10, v160 quad_perm:[0,0,0,0] row_mask:0xf bank_mask:0xf
v_add_f32_dpp v10, v161, v10 quad_perm:[1,1,1,1] row_mask:0xf bank_mask:0xf
v_add_f32_dpp v10, v162, v10 quad_perm:[2,2,2,2] row_mask:0xf bank_mask:0xf
v_add_f32_dpp v10, v163, v10 quad_perm:[3,3,3,3] row_mask:0xf bank_mask:0xf
v_mov_b32_dpp v11, v164 quad_perm:[0,0,0,0] row_mask:0xf bank_mask:0xf
v_add_f32_dpp v11, v165, v11 quad_perm:[1,1,1,1] row_mask:0xf bank_mask:0xf
v_add_f32_dpp v11, v166, v11 quad_perm:[2,2,2,2] row_mask:0xf bank_mask:0xf
v_add_f32_dpp v11, v167, v11 quad_perm:[3,3,3,3] row_mask:0xf bank_mask:0xf
v_mov_b32_dpp v12, v168 quad_perm:[0,0,0,0] row_mask:0xf bank_mask:0xf
v_add_f32_dpp v12, v169, v12 quad_perm:[1,1,1,1] row_mask:0xf bank_mask:0xf
v_add_f32_dpp v12, v170, v12 quad_perm:[2,2,2,2] row_mask:0xf bank_mask:0xf
v_add_f32_dpp v12, v171, v12 quad_perm:[3,3,3,3] row_mask:0xf bank_mask:0xf
v_mov_b32_dpp v13, v172 quad_perm:[0,0,0,0] row_mask:0xf bank_mask:0xf
v_add_f32_dpp v13, v173, v13 quad_perm:[1,1,1,1] row_mask:0xf bank_mask:0xf
v_add_f32_dpp v13, v174, v13 quad_perm:[2,2,2,2] row_mask:0xf bank_mask:0xf
v_add_f32_dpp v13, v175, v13 quad_perm:[3,3,3,3] row_mask:0xf bank_mask:0xf
v_mov_b32_dpp v14, v176 quad_perm:[0,0,0,0] row_mask:0xf bank_mask:0xf
v_add_f32_dpp v14, v177, v14 quad_perm:[1,1,1,1] row_mask:0xf bank_mask:0xf
v_add_f32_dpp v14, v178, v14 quad_perm:[2,2,2,2] row_mask:0xf bank_mask:0xf
v_add_f32_dpp v14, v179, v14 quad_perm:[3,3,3,3] row_mask:0xf bank_mask:0xf
v_mov_b32_dpp v15, v180 quad_perm:[0,0,0,0] row_mask:0xf bank_mask:0xf
v_add_f32_dpp v15, v181, v15 quad_perm:[1,1,1,1] row_mask:0xf bank_mask:0xf
v_add_f32_dpp v15, v182, v15 quad_perm:[2,2,2,2] row_mask:0xf bank_mask:0xf
v_add_f32_dpp v15, v183, v15 quad_perm:[3,3,3,3] row_mask:0xf bank_mask:0xf
v_mov_b32_dpp v16, v184 quad_perm:[0,0,0,0] row_mask:0xf bank_mask:0xf
v_add_f32_dpp v16, v185, v16 quad_perm:[1,1,1,1] row_mask:0xf bank_mask:0xf
v_add_f32_dpp v16, v186, v16 quad_perm:[2,2,2,2] row_mask:0xf bank_mask:0xf
v_add_f32_dpp v16, v187, v16 quad_perm:[3,3,3,3] row_mask:0xf bank_mask:0xf
v_mov_b32_dpp v17, v188 quad_perm:[0,0,0,0] row_mask:0xf bank_mask:0xf
v_add_f32_dpp v17, v189, v17 quad_perm:[1,1,1,1] row_mask:0xf bank_mask:0xf
v_add_f32_dpp v17, v190, v17 quad_perm:[2,2,2,2] row_mask:0xf bank_mask:0xf
v_add_f32_dpp v17, v191, v17 quad_perm:[3,3,3,3] row_mask:0xf bank_mask:0xf
v_cvt_pk_bf16_f32 v27, v10, v11
v_lshlrev_b32 v10, 16, v27
v_and_b32 v11, 0xffff0000, v27
v_cvt_pk_bf16_f32 v27, v12, v13
v_lshlrev_b32 v12, 16, v27
v_and_b32 v13, 0xffff0000, v27
v_cvt_pk_bf16_f32 v27, v14, v15
v_lshlrev_b32 v14, 16, v27
v_and_b32 v15, 0xffff0000, v27
v_cvt_pk_bf16_f32 v27, v16, v17
v_lshlrev_b32 v16, 16, v27
v_and_b32 v17, 0xffff0000, v27
v_max3_f32 v27, v10, v11, v12
v_max3_f32 v27, v27, v13, v14
v_max3_f32 v27, v27, v15, v16
v_max_f32 v27, v27, v17
v_cmp_gt_f32 vcc, v27, v22
s_cbranch_vccz L_FAST
v_mov_b32 v28, v27
v_mov_b32 v29, v27
s_nop 1
v_permlane16_swap_b32 v28, v29
s_nop 1
v_max_f32 v27, v28, v29
v_mov_b32 v28, v27
v_mov_b32 v29, v27
s_nop 1
v_permlane32_swap_b32 v28, v29
s_nop 1
v_max_f32 v27, v28, v29
v_max_f32 v27, v27, v22
v_sub_f32 v28, v22, v27
v_mul_f32 v28, s68, v28
v_exp_f32 v28, v28
v_mov_b32 v22, v27
v_mul_f32 v24, s68, v27
v_mul_f32 v23, v23, v28
ds_bpermute_b32 v29, v30, v28
s_waitcnt lgkmcnt(0)
v_mul_f32 v192, v192, v29
v_mul_f32 v193, v193, v29
v_mul_f32 v194, v194, v29
v_mul_f32 v195, v195, v29
v_mul_f32 v196, v196, v29
v_mul_f32 v197, v197, v29
v_mul_f32 v198, v198, v29
v_mul_f32 v199, v199, v29
v_mul_f32 v200, v200, v29
v_mul_f32 v201, v201, v29
v_mul_f32 v202, v202, v29
v_mul_f32 v203, v203, v29
v_mul_f32 v204, v204, v29
v_mul_f32 v205, v205, v29
v_mul_f32 v206, v206, v29
v_mul_f32 v207, v207, v29
v_mul_f32 v208, v208, v29
v_mul_f32 v209, v209, v29
v_mul_f32 v210, v210, v29
v_mul_f32 v211, v211, v29
v_mul_f32 v212, v212, v29
v_mul_f32 v213, v213, v29
v_mul_f32 v214, v214, v29
v_mul_f32 v215, v215, v29
v_mul_f32 v216, v216, v29
v_mul_f32 v217, v217, v29
v_mul_f32 v218, v218, v29
v_mul_f32 v219, v219, v29
v_mul_f32 v220, v220, v29
v_mul_f32 v221, v221, v29
v_mul_f32 v222, v222, v29
v_mul_f32 v223, v223, v29
v_mul_f32 v224, v224, v29
v_mul_f32 v225, v225, v29
v_mul_f32 v226, v226, v29
v_mul_f32 v227, v227, v29
v_mul_f32 v228, v228, v29
v_mul_f32 v229, v229, v29
v_mul_f32 v230, v230, v29
v_mul_f32 v231, v231, v29
v_mul_f32 v232, v232, v29
v_mul_f32 v233, v233, v29
v_mul_f32 v234, v234, v29
v_mul_f32 v235, v235, v29
v_mul_f32 v236, v236, v29
v_mul_f32 v237, v237, v29
v_mul_f32 v238, v238, v29
v_mul_f32 v239, v239, v29
v_mul_f32 v240, v240, v29
v_mul_f32 v241, v241, v29
v_mul_f32 v242, v242, v29
v_mul_f32 v243, v243, v29
v_mul_f32 v244, v244, v29
v_mul_f32 v245, v245, v29
v_mul_f32 v246, v246, v29
v_mul_f32 v247, v247, v29
v_mul_f32 v248, v248, v29
v_mul_f32 v249, v249, v29
v_mul_f32 v250, v250, v29
v_mul_f32 v251, v251, v29
v_mul_f32 v252, v252, v29
v_mul_f32 v253, v253, v29
v_mul_f32 v254, v254, v29
v_mul_f32 v255, v255, v29
L_FAST:
v_fma_f32 v10, v10, s68, -v24
v_fma_f32 v11, v11, s68, -v24
v_fma_f32 v12, v12, s68, -v24
v_fma_f32 v13, v13, s68, -v24
v_fma_f32 v14, v14, s68, -v24
v_fma_f32 v15, v15, s68, -v24
v_fma_f32 v16, v16, s68, -v24
v_fma_f32 v17, v17, s68, -v24
v_exp_f32 v10, v10
v_exp_f32 v11, v11
v_exp_f32 v12, v12
v_exp_f32 v13, v13
v_exp_f32 v14, v14
v_exp_f32 v15, v15
v_exp_f32 v16, v16
v_exp_f32 v17, v17
s_nop 0
v_cvt_pk_bf16_f32 v18, v10, v11
v_cvt_pk_bf16_f32 v19, v12, v13
v_cvt_pk_bf16_f32 v20, v14, v15
v_cvt_pk_bf16_f32 v21, v16, v17
v_add_f32 v27, v10, v11
v_add_f32 v28, v12, v13
v_add_f32 v29, v14, v15
v_add_f32 v27, v27, v28
v_add_f32 v28, v16, v17
v_add_f32 v29, v29, v28
v_add_f32 v27, v27, v29
v_add_f32 v23, v23, v27
s_cmp_eq_u32 s65, 1
s_cbranch_scc0 L_W16
s_waitcnt vmcnt(0)
L_W16:
s_waitcnt vmcnt(17)
v_perm_b32 v160, v100, v96, s66
v_perm_b32 v164, v100, v96, s67
v_perm_b32 v161, v108, v104, s66
v_perm_b32 v165, v108, v104, s67
v_perm_b32 v162, v116, v112, s66
v_perm_b32 v166, v116, v112, s67
v_perm_b32 v163, v124, v120, s66
v_perm_b32 v167, v124, v120, s67
v_perm_b32 v168, v101, v97, s66
v_perm_b32 v172, v101, v97, s67
v_perm_b32 v169, v109, v105, s66
v_perm_b32 v173, v109, v105, s67
v_perm_b32 v170, v117, v113, s66
v_perm_b32 v174, v117, v113, s67
v_perm_b32 v171, v125, v121, s66
v_perm_b32 v175, v125, v121, s67
v_perm_b32 v176, v102, v98, s66
v_perm_b32 v180, v102, v98, s67
v_perm_b32 v177, v110, v106, s66
v_perm_b32 v181, v110, v106, s67
v_perm_b32 v178, v118, v114, s66
v_perm_b32 v182, v118, v114, s67
v_perm_b32 v179, v126, v122, s66
v_perm_b32 v183, v126, v122, s67
v_perm_b32 v184, v103, v99, s66
v_perm_b32 v188, v103, v99, s67
v_perm_b32 v185, v111, v107, s66
v_perm_b32 v189, v111, v107, s67
v_perm_b32 v186, v119, v115, s66
v_perm_b32 v190, v119, v115, s67
v_perm_b32 v187, v127, v123, s66
v_perm_b32 v191, v127, v123, s67
s_nop 1
v_mfma_f32_16x16x32_bf16 v[192:195], v[18:21], v[160:163], v[192:195]
v_mfma_f32_16x16x32_bf16 v[196:199], v[18:21], v[164:167], v[196:199]
v_mfma_f32_16x16x32_bf16 v[200:203], v[18:21], v[168:171], v[200:203]
v_mfma_f32_16x16x32_bf16 v[204:207], v[18:21], v[172:175], v[204:207]
v_mfma_f32_16x16x32_bf16 v[208:211], v[18:21], v[176:179], v[208:211]
v_mfma_f32_16x16x32_bf16 v[212:215], v[18:21], v[180:183], v[212:215]
v_mfma_f32_16x16x32_bf16 v[216:219], v[18:21], v[184:187], v[216:219]
v_mfma_f32_16x16x32_bf16 v[220:223], v[18:21], v[188:191], v[220:223]
v_perm_b32 v160, v132, v128, s66
v_perm_b32 v164, v132, v128, s67
v_perm_b32 v161, v140, v136, s66
v_perm_b32 v165, v140, v136, s67
v_perm_b32 v162, v148, v144, s66
v_perm_b32 v166, v148, v144, s67
v_perm_b32 v163, v156, v152, s66
v_perm_b32 v167, v156, v152, s67
v_perm_b32 v168, v133, v129, s66
v_perm_b32 v172, v133, v129, s67
v_perm_b32 v169, v141, v137, s66
v_perm_b32 v173, v141, v137, s67
v_perm_b32 v170, v149, v145, s66
v_perm_b32 v174, v149, v145, s67
v_perm_b32 v171, v157, v153, s66
v_perm_b32 v175, v157, v153, s67
v_perm_b32 v176, v134, v130, s66
v_perm_b32 v180, v134, v130, s67
v_perm_b32 v177, v142, v138, s66
v_perm_b32 v181, v142, v138, s67
v_perm_b32 v178, v150, v146, s66
v_perm_b32 v182, v150, v146, s67
v_perm_b32 v179, v158, v154, s66
v_perm_b32 v183, v158, v154, s67
v_perm_b32 v184, v135, v131, s66
v_perm_b32 v188, v135, v131, s67
v_perm_b32 v185, v143, v139, s66
v_perm_b32 v189, v143, v139, s67
v_perm_b32 v186, v151, v147, s66
v_perm_b32 v190, v151, v147, s67
v_perm_b32 v187, v159, v155, s66
v_perm_b32 v191, v159, v155, s67
s_cmp_eq_u32 s65, 1
s_cbranch_scc1 L_SKIPV
buffer_load_dwordx4 v[96:99], v26, s[36:39], s64 offen offset:0 nt
buffer_load_dwordx4 v[100:103], v26, s[36:39], s64 offen offset:512 nt
buffer_load_dwordx4 v[104:107], v26, s[36:39], s64 offen offset:1024 nt
buffer_load_dwordx4 v[108:111], v26, s[36:39], s64 offen offset:1536 nt
buffer_load_dwordx4 v[112:115], v26, s[36:39], s64 offen offset:2048 nt
buffer_load_dwordx4 v[116:119], v26, s[36:39], s64 offen offset:2560 nt
buffer_load_dwordx4 v[120:123], v26, s[36:39], s64 offen offset:3072 nt
buffer_load_dwordx4 v[124:127], v26, s[36:39], s64 offen offset:3584 nt
buffer_load_dwordx4 v[128:131], v26, s[36:39], s64 offen offset:256 nt
buffer_load_dwordx4 v[132:135], v26, s[36:39], s64 offen offset:768 nt
buffer_load_dwordx4 v[136:139], v26, s[36:39], s64 offen offset:1280 nt
buffer_load_dwordx4 v[140:143], v26, s[36:39], s64 offen offset:1792 nt
buffer_load_dwordx4 v[144:147], v26, s[36:39], s64 offen offset:2304 nt
buffer_load_dwordx4 v[148:151], v26, s[36:39], s64 offen offset:2816 nt
buffer_load_dwordx4 v[152:155], v26, s[36:39], s64 offen offset:3328 nt
buffer_load_dwordx4 v[156:159], v26, s[36:39], s64 offen offset:3840 nt
L_SKIPV:
s_nop 1
v_mfma_f32_16x16x32_bf16 v[224:227], v[18:21], v[160:163], v[224:227]
v_mfma_f32_16x16x32_bf16 v[228:231], v[18:21], v[164:167], v[228:231]
v_mfma_f32_16x16x32_bf16 v[232:235], v[18:21], v[168:171], v[232:235]
v_mfma_f32_16x16x32_bf16 v[236:239], v[18:21], v[172:175], v[236:239]
v_mfma_f32_16x16x32_bf16 v[240:243], v[18:21], v[176:179], v[240:243]
v_mfma_f32_16x16x32_bf16 v[244:247], v[18:21], v[180:183], v[244:247]
v_mfma_f32_16x16x32_bf16 v[248:251], v[18:21], v[184:187], v[248:251]
v_mfma_f32_16x16x32_bf16 v[252:255], v[18:21], v[188:191], v[252:255]
s_cmp_eq_u32 s65, 0
s_cbranch_scc1 L_LOOP
v_mov_b32 v28, v23
v_mov_b32 v29, v23
s_nop 1
v_permlane16_swap_b32 v28, v29
s_nop 1
v_add_f32 v23, v28, v29
v_mov_b32 v28, v23
v_mov_b32 v29, v23
s_nop 1
v_permlane32_swap_b32 v28, v29
s_nop 1
v_add_f32 v23, v28, v29
v_and_b32 v27, 15, v1
v_lshrrev_b32 v28, 4, v1
v_lshlrev_b32 v29, 10, v28
v_lshl_add_u32 v29, v27, 5, v29
s_lshl_b32 s69, s3, 11
s_add_u32 s69, s69, 122880
v_add_u32 v29, s69, v29
v_cmp_gt_u32 vcc, 32, v1
s_and_saveexec_b64 s[72:73], vcc
ds_write_b32 v29, v192 offset:0
ds_write_b32 v29, v196 offset:4
ds_write_b32 v29, v200 offset:8
ds_write_b32 v29, v204 offset:12
ds_write_b32 v29, v208 offset:16
ds_write_b32 v29, v212 offset:20
ds_write_b32 v29, v216 offset:24
ds_write_b32 v29, v220 offset:28
ds_write_b32 v29, v224 offset:512
ds_write_b32 v29, v228 offset:516
ds_write_b32 v29, v232 offset:520
ds_write_b32 v29, v236 offset:524
ds_write_b32 v29, v240 offset:528
ds_write_b32 v29, v244 offset:532
ds_write_b32 v29, v248 offset:536
ds_write_b32 v29, v252 offset:540
s_mov_b64 exec, s[72:73]
v_lshlrev_b32 v29, 1, v1
s_lshl_b32 s69, s3, 4
s_add_u32 s69, s69, 139264
v_add_u32 v29, s69, v29
v_and_b32 v27, 0xfb, v1
v_cmp_eq_u32 vcc, 0, v27
s_and_saveexec_b64 s[72:73], vcc
ds_write_b64 v29, v[22:23]
s_mov_b64 exec, s[72:73]
s_add_u32 s40, s28, 131072
s_addc_u32 s41, s29, 0
s_and_b32 s41, s41, 0xffff
s_mov_b32 s42, 1056768
s_mov_b32 s43, 0x00020000
s_add_u32 s52, s28, 1245184
s_addc_u32 s53, s29, 0
s_and_b32 s53, s53, 0xffff
s_mov_b32 s54, 229376
s_mov_b32 s55, 0x00020000
v_lshrrev_b32 v2, 8, v0
v_lshlrev_b32 v3, 3, v2
v_add_u32 v3, 139264, v3
v_lshlrev_b32 v4, 2, v0
v_add_u32 v5, 122880, v4
v_and_b32 v9, 0xfffffffe, v0
v_lshlrev_b32 v9, 3, v9
v_mov_b32 v14, s78
v_mov_b32 v15, s79
v_mov_b32 v18, s78
v_mov_b32 v19, s79
s_waitcnt lgkmcnt(0)
s_barrier
ds_read_b64 v[96:97], v3 offset:0
ds_read_b64 v[98:99], v3 offset:16
ds_read_b64 v[100:101], v3 offset:32
ds_read_b64 v[102:103], v3 offset:48
ds_read_b64 v[104:105], v3 offset:64
ds_read_b64 v[106:107], v3 offset:80
ds_read_b64 v[108:109], v3 offset:96
ds_read_b64 v[110:111], v3 offset:112
ds_read_b32 v112, v5 offset:0
ds_read_b32 v113, v5 offset:2048
ds_read_b32 v114, v5 offset:4096
ds_read_b32 v115, v5 offset:6144
ds_read_b32 v116, v5 offset:8192
ds_read_b32 v117, v5 offset:10240
ds_read_b32 v118, v5 offset:12288
ds_read_b32 v119, v5 offset:14336
s_lshl_b32 s69, s63, 2
s_add_u32 s69, s69, s62
s_mul_i32 s69, s69, 4128
v_lshlrev_b32 v8, 4, v2
v_add_u32 v8, 4096, v8
s_waitcnt lgkmcnt(0)
v_max3_f32 v16, v96, v98, v100
v_max3_f32 v16, v16, v102, v104
v_max3_f32 v16, v16, v106, v108
v_max_f32 v16, v16, v110
v_sub_f32 v96, v96, v16
v_mul_f32 v96, s68, v96
v_exp_f32 v96, v96
v_sub_f32 v98, v98, v16
v_mul_f32 v98, s68, v98
v_exp_f32 v98, v98
v_sub_f32 v100, v100, v16
v_mul_f32 v100, s68, v100
v_exp_f32 v100, v100
v_sub_f32 v102, v102, v16
v_mul_f32 v102, s68, v102
v_exp_f32 v102, v102
v_sub_f32 v104, v104, v16
v_mul_f32 v104, s68, v104
v_exp_f32 v104, v104
v_sub_f32 v106, v106, v16
v_mul_f32 v106, s68, v106
v_exp_f32 v106, v106
v_sub_f32 v108, v108, v16
v_mul_f32 v108, s68, v108
v_exp_f32 v108, v108
v_sub_f32 v110, v110, v16
v_mul_f32 v110, s68, v110
v_exp_f32 v110, v110
s_nop 0
v_mul_f32 v17, v96, v97
v_mul_f32 v12, v96, v112
v_fmac_f32 v17, v98, v99
v_fmac_f32 v12, v98, v113
v_fmac_f32 v17, v100, v101
v_fmac_f32 v12, v100, v114
v_fmac_f32 v17, v102, v103
v_fmac_f32 v12, v102, v115
v_fmac_f32 v17, v104, v105
v_fmac_f32 v12, v104, v116
v_fmac_f32 v17, v106, v107
v_fmac_f32 v12, v106, v117
v_fmac_f32 v17, v108, v109
v_fmac_f32 v12, v108, v118
v_fmac_f32 v17, v110, v111
v_fmac_f32 v12, v110, v119
s_nop 1
v_mov_b32_dpp v13, v12 quad_perm:[1,0,3,2] row_mask:0xf bank_mask:0xf
s_mov_b32 exec_lo, 0x55555555
s_mov_b32 exec_hi, 0x55555555
buffer_store_dwordx4 v[12:15], v9, s[40:43], s69 offen sc1
s_mov_b64 exec, -1
v_and_b32 v6, 255, v0
v_cmp_eq_u32 vcc, 0, v6
s_and_saveexec_b64 s[72:73], vcc
buffer_store_dwordx4 v[16:19], v8, s[40:43], s69 offen sc1
s_mov_b64 exec, s[72:73]
v_lshrrev_b32 v12, 4, v1
v_bfe_u32 v13, v1, 2, 2
v_lshl_add_u32 v13, v12, 3, v13
v_mul_u32_u24 v20, 224, v13
v_and_b32 v13, 3, v1
v_lshl_add_u32 v20, v13, 3, v20
s_mul_i32 s70, s3, 14336
v_add_u32 v20, s70, v20
v_lshlrev_b32 v21, 4, v12
s_lshl_b32 s70, s3, 7
s_add_u32 s70, s70, 139392
v_add_u32 v21, s70, v21
v_lshlrev_b32 v22, 2, v1
s_mul_i32 s70, s3, 448
s_add_u32 s70, s70, 122880
v_add_u32 v22, s70, v22
v_lshlrev_b32 v6, 1, v0
v_add_u32 v6, 139392, v6
v_lshlrev_b32 v128, 16, v32
v_and_b32 v129, 0xffff0000, v32
v_lshlrev_b32 v130, 16, v33
v_and_b32 v131, 0xffff0000, v33
v_lshlrev_b32 v132, 16, v34
v_and_b32 v133, 0xffff0000, v34
v_lshlrev_b32 v134, 16, v35
v_and_b32 v135, 0xffff0000, v35
v_lshlrev_b32 v136, 16, v36
v_and_b32 v137, 0xffff0000, v36
v_lshlrev_b32 v138, 16, v37
v_and_b32 v139, 0xffff0000, v37
v_lshlrev_b32 v140, 16, v38
v_and_b32 v141, 0xffff0000, v38
v_lshlrev_b32 v142, 16, v39
v_and_b32 v143, 0xffff0000, v39
v_lshlrev_b32 v144, 16, v40
v_and_b32 v145, 0xffff0000, v40
v_lshlrev_b32 v146, 16, v41
v_and_b32 v147, 0xffff0000, v41
v_lshlrev_b32 v148, 16, v42
v_and_b32 v149, 0xffff0000, v42
v_lshlrev_b32 v150, 16, v43
v_and_b32 v151, 0xffff0000, v43
v_lshlrev_b32 v152, 16, v44
v_and_b32 v153, 0xffff0000, v44
v_lshlrev_b32 v154, 16, v45
v_and_b32 v155, 0xffff0000, v45
v_lshlrev_b32 v156, 16, v46
v_and_b32 v157, 0xffff0000, v46
v_lshlrev_b32 v158, 16, v47
v_and_b32 v159, 0xffff0000, v47
v_lshlrev_b32 v160, 16, v48
v_and_b32 v161, 0xffff0000, v48
v_lshlrev_b32 v162, 16, v49
v_and_b32 v163, 0xffff0000, v49
v_lshlrev_b32 v164, 16, v50
v_and_b32 v165, 0xffff0000, v50
v_lshlrev_b32 v166, 16, v51
v_and_b32 v167, 0xffff0000, v51
v_lshlrev_b32 v168, 16, v52
v_and_b32 v169, 0xffff0000, v52
v_lshlrev_b32 v170, 16, v53
v_and_b32 v171, 0xffff0000, v53
v_lshlrev_b32 v172, 16, v54
v_and_b32 v173, 0xffff0000, v54
v_lshlrev_b32 v174, 16, v55
v_and_b32 v175, 0xffff0000, v55
v_lshlrev_b32 v176, 16, v56
v_and_b32 v177, 0xffff0000, v56
v_lshlrev_b32 v178, 16, v57
v_and_b32 v179, 0xffff0000, v57
v_lshlrev_b32 v180, 16, v58
v_and_b32 v181, 0xffff0000, v58
v_lshlrev_b32 v182, 16, v59
v_and_b32 v183, 0xffff0000, v59
v_lshlrev_b32 v184, 16, v60
v_and_b32 v185, 0xffff0000, v60
v_lshlrev_b32 v186, 16, v61
v_and_b32 v187, 0xffff0000, v61
v_lshlrev_b32 v188, 16, v62
v_and_b32 v189, 0xffff0000, v62
v_lshlrev_b32 v190, 16, v63
v_and_b32 v191, 0xffff0000, v63
v_lshlrev_b32 v192, 16, v64
v_and_b32 v193, 0xffff0000, v64
v_lshlrev_b32 v194, 16, v65
v_and_b32 v195, 0xffff0000, v65
v_lshlrev_b32 v196, 16, v66
v_and_b32 v197, 0xffff0000, v66
v_lshlrev_b32 v198, 16, v67
v_and_b32 v199, 0xffff0000, v67
v_lshlrev_b32 v200, 16, v68
v_and_b32 v201, 0xffff0000, v68
v_lshlrev_b32 v202, 16, v69
v_and_b32 v203, 0xffff0000, v69
v_lshlrev_b32 v204, 16, v70
v_and_b32 v205, 0xffff0000, v70
v_lshlrev_b32 v206, 16, v71
v_and_b32 v207, 0xffff0000, v71
v_lshlrev_b32 v208, 16, v72
v_and_b32 v209, 0xffff0000, v72
v_lshlrev_b32 v210, 16, v73
v_and_b32 v211, 0xffff0000, v73
s_mul_i32 s69, s63, 16512
s_cmp_lg_u32 s3, 0
s_cbranch_scc1 L_H1_DONE
v_lshrrev_b32 v10, 1, v1
v_mul_u32_u24 v10, 4128, v10
v_and_b32 v11, 1, v1
v_lshl_add_u32 v10, v11, 4, v10
v_add_u32 v10, 4096, v10
v_lshlrev_b32 v11, 3, v1
v_add_u32 v11, 145296, v11
s_mov_b64 exec, 0xff
L_H1_RETRY:
buffer_load_dwordx4 v[96:99], v10, s[40:43], s69 offen sc1
s_waitcnt vmcnt(0)
s_mov_b64 s[72:73], exec
v_cmp_eq_u64 vcc, s[78:79], v[98:99]
s_and_b64 s[72:73], s[72:73], vcc
s_cmp_eq_u64 s[72:73], exec
s_cbranch_scc1 L_H1_OK
s_sleep 4
s_branch L_H1_RETRY
L_H1_OK:
ds_write_b64 v11, v[96:97]
s_mov_b64 exec, -1
s_waitcnt lgkmcnt(0)
L_H1_DONE:
s_barrier
v_lshlrev_b32 v3, 3, v2
v_add_u32 v3, 145296, v3
ds_read_b64 v[112:113], v3 offset:0
ds_read_b64 v[114:115], v3 offset:16
ds_read_b64 v[116:117], v3 offset:32
ds_read_b64 v[118:119], v3 offset:48
L_T2_RETRY:
s_mov_b32 s70, s69
buffer_load_dwordx4 v[96:99], v9, s[40:43], s70 offen sc1
s_add_u32 s70, s70, 4128
buffer_load_dwordx4 v[100:103], v9, s[40:43], s70 offen sc1
s_add_u32 s70, s70, 4128
buffer_load_dwordx4 v[104:107], v9, s[40:43], s70 offen sc1
s_add_u32 s70, s70, 4128
buffer_load_dwordx4 v[108:111], v9, s[40:43], s70 offen sc1
s_add_u32 s70, s70, 4128
s_waitcnt vmcnt(0)
s_mov_b64 s[72:73], exec
v_cmp_eq_u64 vcc, s[78:79], v[98:99]
s_and_b64 s[72:73], s[72:73], vcc
v_cmp_eq_u64 vcc, s[78:79], v[102:103]
s_and_b64 s[72:73], s[72:73], vcc
v_cmp_eq_u64 vcc, s[78:79], v[106:107]
s_and_b64 s[72:73], s[72:73], vcc
v_cmp_eq_u64 vcc, s[78:79], v[110:111]
s_and_b64 s[72:73], s[72:73], vcc
s_cmp_eq_u64 s[72:73], exec
s_cbranch_scc1 L_T2_OK
s_sleep 1
s_branch L_T2_RETRY
L_T2_OK:
v_and_b32 v7, 1, v0
v_cmp_eq_u32 vcc, 1, v7
s_waitcnt lgkmcnt(0)
s_nop 0
v_cndmask_b32 v96, v96, v97, vcc
v_cndmask_b32 v100, v100, v101, vcc
v_cndmask_b32 v104, v104, v105, vcc
v_cndmask_b32 v108, v108, v109, vcc
v_max3_f32 v10, v112, v114, v116
v_max_f32 v10, v10, v118
v_sub_f32 v112, v112, v10
v_mul_f32 v112, s68, v112
v_exp_f32 v112, v112
v_sub_f32 v114, v114, v10
v_mul_f32 v114, s68, v114
v_exp_f32 v114, v114
v_sub_f32 v116, v116, v10
v_mul_f32 v116, s68, v116
v_exp_f32 v116, v116
v_sub_f32 v118, v118, v10
v_mul_f32 v118, s68, v118
v_exp_f32 v118, v118
s_nop 0
v_mul_f32 v11, v112, v113
v_mul_f32 v7, v112, v96
v_fmac_f32 v11, v114, v115
v_fmac_f32 v7, v114, v100
v_fmac_f32 v11, v116, v117
v_fmac_f32 v7, v116, v104
v_fmac_f32 v11, v118, v119
v_fmac_f32 v7, v118, v108
v_rcp_f32 v10, v11
s_nop 0
v_mul_f32 v8, v7, v10
v_fma_f32 v7, -v8, v11, v7
v_fma_f32 v8, v7, v10, v8
v_cvt_pk_bf16_f32 v8, v8, v8
ds_write_b16 v6, v8
s_waitcnt lgkmcnt(0)
s_barrier
ds_read_b128 v[96:99], v21
ds_read_b128 v[100:103], v21 offset:64
ds_read_b64_tr_b16 v[212:213], v20 offset:0
ds_read_b64_tr_b16 v[214:215], v20 offset:896
ds_read_b64_tr_b16 v[216:217], v20 offset:32
ds_read_b64_tr_b16 v[218:219], v20 offset:928
ds_read_b64_tr_b16 v[220:221], v20 offset:64
ds_read_b64_tr_b16 v[222:223], v20 offset:960
ds_read_b64_tr_b16 v[224:225], v20 offset:96
ds_read_b64_tr_b16 v[226:227], v20 offset:992
ds_read_b64_tr_b16 v[228:229], v20 offset:128
ds_read_b64_tr_b16 v[230:231], v20 offset:1024
ds_read_b64_tr_b16 v[232:233], v20 offset:160
ds_read_b64_tr_b16 v[234:235], v20 offset:1056
ds_read_b64_tr_b16 v[236:237], v20 offset:192
ds_read_b64_tr_b16 v[238:239], v20 offset:1088
ds_read_b64_tr_b16 v[240:241], v20 offset:7168
ds_read_b64_tr_b16 v[242:243], v20 offset:8064
ds_read_b64_tr_b16 v[244:245], v20 offset:7200
ds_read_b64_tr_b16 v[246:247], v20 offset:8096
ds_read_b64_tr_b16 v[248:249], v20 offset:7232
ds_read_b64_tr_b16 v[250:251], v20 offset:8128
ds_read_b64_tr_b16 v[252:253], v20 offset:7264
ds_read_b64_tr_b16 v[254:255], v20 offset:8160
ds_read_b64_tr_b16 v[104:105], v20 offset:7296
ds_read_b64_tr_b16 v[106:107], v20 offset:8192
ds_read_b64_tr_b16 v[108:109], v20 offset:7328
ds_read_b64_tr_b16 v[110:111], v20 offset:8224
ds_read_b64_tr_b16 v[112:113], v20 offset:7360
ds_read_b64_tr_b16 v[114:115], v20 offset:8256
s_waitcnt lgkmcnt(0)
v_mfma_f32_16x16x32_bf16 v[32:35], v[96:99], v[212:215], 0
v_mfma_f32_16x16x32_bf16 v[36:39], v[96:99], v[216:219], 0
v_mfma_f32_16x16x32_bf16 v[40:43], v[96:99], v[220:223], 0
v_mfma_f32_16x16x32_bf16 v[44:47], v[96:99], v[224:227], 0
v_mfma_f32_16x16x32_bf16 v[48:51], v[96:99], v[228:231], 0
v_mfma_f32_16x16x32_bf16 v[52:55], v[96:99], v[232:235], 0
v_mfma_f32_16x16x32_bf16 v[56:59], v[96:99], v[236:239], 0
v_mfma_f32_16x16x32_bf16 v[32:35], v[100:103], v[240:243], v[32:35]
v_mfma_f32_16x16x32_bf16 v[36:39], v[100:103], v[244:247], v[36:39]
v_mfma_f32_16x16x32_bf16 v[40:43], v[100:103], v[248:251], v[40:43]
v_mfma_f32_16x16x32_bf16 v[44:47], v[100:103], v[252:255], v[44:47]
v_mfma_f32_16x16x32_bf16 v[48:51], v[100:103], v[104:107], v[48:51]
v_mfma_f32_16x16x32_bf16 v[52:55], v[100:103], v[108:111], v[52:55]
v_mfma_f32_16x16x32_bf16 v[56:59], v[100:103], v[112:115], v[56:59]
s_mov_b64 exec, 0xffff
s_nop 7
ds_write_b32 v22, v32 offset:0
ds_write_b32 v22, v36 offset:64
ds_write_b32 v22, v40 offset:128
ds_write_b32 v22, v44 offset:192
ds_write_b32 v22, v48 offset:256
ds_write_b32 v22, v52 offset:320
ds_write_b32 v22, v56 offset:384
s_mov_b64 exec, -1
s_waitcnt lgkmcnt(0)
s_barrier
s_mul_i32 s69, s61, 28672
s_cmp_ge_u32 s3, 2
s_cbranch_scc1 L_T3B
ds_read_b32 v96, v5 offset:0
ds_read_b32 v97, v5 offset:448
ds_read_b32 v98, v5 offset:896
ds_read_b32 v99, v5 offset:1344
ds_read_b32 v100, v5 offset:1792
ds_read_b32 v101, v5 offset:2240
ds_read_b32 v102, v5 offset:2688
ds_read_b32 v103, v5 offset:3136
s_mul_i32 s70, s60, 3584
s_mul_i32 s71, s62, 896
s_add_u32 s70, s70, s71
s_add_u32 s70, s70, s69
v_cmp_gt_u32 vcc, 112, v0
s_and_b32 vcc_lo, vcc_lo, 0x55555555
s_and_b32 vcc_hi, vcc_hi, 0x55555555
s_waitcnt lgkmcnt(0)
v_add_f32 v96, v96, v100
v_add_f32 v97, v97, v101
v_add_f32 v98, v98, v102
v_add_f32 v99, v99, v103
v_add_f32 v96, v96, v98
v_add_f32 v97, v97, v99
v_add_f32 v12, v96, v97
s_nop 1
v_mov_b32_dpp v13, v12 quad_perm:[1,0,3,2] row_mask:0xf bank_mask:0xf
s_and_saveexec_b64 s[72:73], vcc
buffer_store_dwordx4 v[12:15], v9, s[52:55], s70 offen sc1
s_mov_b64 exec, s[72:73]
L_T3B:
s_cmp_lg_u32 s3, 0
s_cbranch_scc1 L_H2_DONE
v_mul_u32_u24 v10, 896, v1
v_add_u32 v10, 880, v10
s_mov_b32 exec_hi, 0
L_H2_RETRY:
buffer_load_dwordx4 v[96:99], v10, s[52:55], s69 offen sc1
s_waitcnt vmcnt(0)
s_mov_b64 s[72:73], exec
v_cmp_eq_u64 vcc, s[78:79], v[98:99]
s_and_b64 s[72:73], s[72:73], vcc
s_cmp_eq_u64 s[72:73], exec
s_cbranch_scc1 L_H2_OK
s_sleep 4
s_branch L_H2_RETRY
L_H2_OK:
s_mov_b64 exec, -1
L_H2_DONE:
s_barrier
s_cmp_eq_u32 s3, 7
s_cbranch_scc1 L_T4SKIP
L_T4_RETRY:
s_mov_b32 s70, s69
buffer_load_dwordx4 v[96:99], v9, s[52:55], s70 offen sc1
s_add_u32 s70, s70, 3584
buffer_load_dwordx4 v[100:103], v9, s[52:55], s70 offen sc1
s_add_u32 s70, s70, 3584
buffer_load_dwordx4 v[104:107], v9, s[52:55], s70 offen sc1
s_add_u32 s70, s70, 3584
buffer_load_dwordx4 v[108:111], v9, s[52:55], s70 offen sc1
s_add_u32 s70, s70, 3584
buffer_load_dwordx4 v[112:115], v9, s[52:55], s70 offen sc1
s_add_u32 s70, s70, 3584
buffer_load_dwordx4 v[116:119], v9, s[52:55], s70 offen sc1
s_add_u32 s70, s70, 3584
buffer_load_dwordx4 v[120:123], v9, s[52:55], s70 offen sc1
s_add_u32 s70, s70, 3584
buffer_load_dwordx4 v[124:127], v9, s[52:55], s70 offen sc1
s_add_u32 s70, s70, 3584
s_waitcnt vmcnt(0)
s_mov_b64 s[72:73], exec
v_cmp_eq_u64 vcc, s[78:79], v[98:99]
s_and_b64 s[72:73], s[72:73], vcc
v_cmp_eq_u64 vcc, s[78:79], v[102:103]
s_and_b64 s[72:73], s[72:73], vcc
v_cmp_eq_u64 vcc, s[78:79], v[106:107]
s_and_b64 s[72:73], s[72:73], vcc
v_cmp_eq_u64 vcc, s[78:79], v[110:111]
s_and_b64 s[72:73], s[72:73], vcc
v_cmp_eq_u64 vcc, s[78:79], v[114:115]
s_and_b64 s[72:73], s[72:73], vcc
v_cmp_eq_u64 vcc, s[78:79], v[118:119]
s_and_b64 s[72:73], s[72:73], vcc
v_cmp_eq_u64 vcc, s[78:79], v[122:123]
s_and_b64 s[72:73], s[72:73], vcc
v_cmp_eq_u64 vcc, s[78:79], v[126:127]
s_and_b64 s[72:73], s[72:73], vcc
s_cmp_eq_u64 s[72:73], exec
s_cbranch_scc1 L_T4_OK
s_sleep 1
s_branch L_T4_RETRY
L_T4_OK:
v_and_b32 v7, 1, v0
v_cmp_eq_u32 vcc, 1, v7
v_add_u32 v5, 143488, v4
s_nop 0
v_cndmask_b32 v96, v96, v97, vcc
v_cndmask_b32 v100, v100, v101, vcc
v_cndmask_b32 v104, v104, v105, vcc
v_cndmask_b32 v108, v108, v109, vcc
v_cndmask_b32 v112, v112, v113, vcc
v_cndmask_b32 v116, v116, v117, vcc
v_cndmask_b32 v120, v120, v121, vcc
v_cndmask_b32 v124, v124, v125, vcc
v_add_f32 v96, v96, v100
v_add_f32 v104, v104, v108
v_add_f32 v112, v112, v116
v_add_f32 v120, v120, v124
v_add_f32 v96, v96, v104
v_add_f32 v112, v112, v120
v_add_f32 v96, v96, v112
v_cvt_pk_bf16_f32 v97, v96, v96
v_lshlrev_b32 v96, 16, v97
v_lshlrev_b32 v74, 16, v74
v_add_f32 v96, v96, v74
v_cvt_pk_bf16_f32 v97, v96, v96
v_lshlrev_b32 v96, 16, v97
ds_write_b32 v5, v96
s_waitcnt lgkmcnt(0)
L_T4SKIP:
s_barrier
s_cmp_eq_u32 s3, 7
s_cbranch_scc1 L_END
v_lshlrev_b32 v6, 2, v1
v_add_u32 v6, 143488, v6
ds_read_b32 v10, v6 offset:0
ds_read_b32 v11, v6 offset:256
ds_read_b32 v12, v6 offset:512
ds_read_b32 v13, v6 offset:768
ds_read_b32 v14, v6 offset:1024
ds_read_b32 v15, v6 offset:1280
ds_read_b32 v16, v6 offset:1536
s_lshl_b32 s69, s62, 3
s_add_u32 s69, s69, s60
s_mul_i32 s69, s69, 14
s_lshl_b32 s70, s3, 1
s_add_u32 s69, s69, s70
s_lshl_b32 s70, s69, 2
s_add_u32 s70, s70, 143488
v_mov_b32 v7, s70
ds_read_b64 v[34:35], v7
s_waitcnt lgkmcnt(0)
v_add_f32 v2, v10, v11
v_add_f32 v2, v2, v12
v_add_f32 v2, v2, v13
v_add_f32 v2, v2, v14
v_add_f32 v2, v2, v15
v_add_f32 v2, v2, v16
s_nop 1
v_add_f32_dpp v2, v2, v2 quad_perm:[1,0,3,2] row_mask:0xf bank_mask:0xf
s_nop 1
v_add_f32_dpp v2, v2, v2 quad_perm:[2,3,0,1] row_mask:0xf bank_mask:0xf
s_nop 1
v_add_f32_dpp v2, v2, v2 row_half_mirror row_mask:0xf bank_mask:0xf
s_nop 1
v_add_f32_dpp v2, v2, v2 row_mirror row_mask:0xf bank_mask:0xf
v_mov_b32 v3, v2
v_mov_b32 v4, v2
s_nop 1
v_permlane16_swap_b32 v3, v4
s_nop 1
v_add_f32 v2, v3, v4
v_mov_b32 v3, v2
v_mov_b32 v4, v2
s_nop 1
v_permlane32_swap_b32 v3, v4
s_nop 1
v_add_f32 v2, v3, v4
v_mul_f32 v5, 0x3b124925, v2
v_sub_f32 v6, v10, v5
v_mul_f32 v2, v6, v6
v_sub_f32 v6, v11, v5
v_fmac_f32 v2, v6, v6
v_sub_f32 v6, v12, v5
v_fmac_f32 v2, v6, v6
v_sub_f32 v6, v13, v5
v_fmac_f32 v2, v6, v6
v_sub_f32 v6, v14, v5
v_fmac_f32 v2, v6, v6
v_sub_f32 v6, v15, v5
v_fmac_f32 v2, v6, v6
v_sub_f32 v6, v16, v5
v_fmac_f32 v2, v6, v6
s_nop 1
v_add_f32_dpp v2, v2, v2 quad_perm:[1,0,3,2] row_mask:0xf bank_mask:0xf
s_nop 1
v_add_f32_dpp v2, v2, v2 quad_perm:[2,3,0,1] row_mask:0xf bank_mask:0xf
s_nop 1
v_add_f32_dpp v2, v2, v2 row_half_mirror row_mask:0xf bank_mask:0xf
s_nop 1
v_add_f32_dpp v2, v2, v2 row_mirror row_mask:0xf bank_mask:0xf
v_mov_b32 v3, v2
v_mov_b32 v4, v2
s_nop 1
v_permlane16_swap_b32 v3, v4
s_nop 1
v_add_f32 v2, v3, v4
v_mov_b32 v3, v2
v_mov_b32 v4, v2
s_nop 1
v_permlane32_swap_b32 v3, v4
s_nop 1
v_add_f32 v2, v3, v4
v_mul_f32 v2, 0x3b124925, v2
v_cvt_pk_bf16_f32 v3, v5, v2
v_lshlrev_b32 v5, 16, v3
v_and_b32 v2, 0xffff0000, v3
v_add_f32 v2, 0x3727c5ac, v2
v_cvt_pk_bf16_f32 v3, v2, v2
v_lshlrev_b32 v2, 16, v3
v_sqrt_f32 v2, v2
s_nop 0
v_cvt_pk_bf16_f32 v3, v2, v2
v_lshlrev_b32 v2, 16, v3
v_rcp_f32 v7, v2
s_nop 0
v_sub_f32 v10, v10, v5
v_sub_f32 v11, v11, v5
v_sub_f32 v12, v12, v5
v_sub_f32 v13, v13, v5
v_sub_f32 v14, v14, v5
v_sub_f32 v15, v15, v5
v_sub_f32 v16, v16, v5
v_cvt_pk_bf16_f32 v3, v10, v11
v_lshlrev_b32 v10, 16, v3
v_and_b32 v11, 0xffff0000, v3
v_cvt_pk_bf16_f32 v3, v12, v13
v_lshlrev_b32 v12, 16, v3
v_and_b32 v13, 0xffff0000, v3
v_cvt_pk_bf16_f32 v3, v14, v15
v_lshlrev_b32 v14, 16, v3
v_and_b32 v15, 0xffff0000, v3
v_cvt_pk_bf16_f32 v3, v16, v16
v_lshlrev_b32 v16, 16, v3
v_mul_f32 v10, v10, v7
v_mul_f32 v11, v11, v7
v_mul_f32 v12, v12, v7
v_mul_f32 v13, v13, v7
v_mul_f32 v14, v14, v7
v_mul_f32 v15, v15, v7
v_mul_f32 v16, v16, v7
v_cvt_pk_bf16_f32 v3, v10, v11
v_lshlrev_b32 v10, 16, v3
v_and_b32 v11, 0xffff0000, v3
v_cvt_pk_bf16_f32 v3, v12, v13
v_lshlrev_b32 v12, 16, v3
v_and_b32 v13, 0xffff0000, v3
v_cvt_pk_bf16_f32 v3, v14, v15
v_lshlrev_b32 v14, 16, v3
v_and_b32 v15, 0xffff0000, v3
v_cvt_pk_bf16_f32 v3, v16, v16
v_lshlrev_b32 v16, 16, v3
v_add_f32 v2, v10, v11
v_mul_f32 v3, v10, v10
v_fmac_f32 v3, v11, v11
v_add_f32 v2, v2, v12
v_fmac_f32 v3, v12, v12
v_add_f32 v2, v2, v13
v_fmac_f32 v3, v13, v13
v_add_f32 v2, v2, v14
v_fmac_f32 v3, v14, v14
v_add_f32 v2, v2, v15
v_fmac_f32 v3, v15, v15
v_add_f32 v2, v2, v16
v_fmac_f32 v3, v16, v16
s_and_b32 s70, s69, 63
s_lshr_b32 s71, s69, 6
s_add_u32 s74, s69, 1
s_and_b32 s75, s74, 63
s_lshr_b32 s76, s74, 6
v_mov_b32 v36, v10
v_mov_b32 v37, v10
s_cmp_eq_u32 s71, 1
s_cselect_b64 s[72:73], -1, 0
v_cndmask_b32 v36, v36, v11, s[72:73]
s_cmp_eq_u32 s76, 1
s_cselect_b64 s[72:73], -1, 0
v_cndmask_b32 v37, v37, v11, s[72:73]
s_cmp_eq_u32 s71, 2
s_cselect_b64 s[72:73], -1, 0
v_cndmask_b32 v36, v36, v12, s[72:73]
s_cmp_eq_u32 s76, 2
s_cselect_b64 s[72:73], -1, 0
v_cndmask_b32 v37, v37, v12, s[72:73]
s_cmp_eq_u32 s71, 3
s_cselect_b64 s[72:73], -1, 0
v_cndmask_b32 v36, v36, v13, s[72:73]
s_cmp_eq_u32 s76, 3
s_cselect_b64 s[72:73], -1, 0
v_cndmask_b32 v37, v37, v13, s[72:73]
s_cmp_eq_u32 s71, 4
s_cselect_b64 s[72:73], -1, 0
v_cndmask_b32 v36, v36, v14, s[72:73]
s_cmp_eq_u32 s76, 4
s_cselect_b64 s[72:73], -1, 0
v_cndmask_b32 v37, v37, v14, s[72:73]
s_cmp_eq_u32 s71, 5
s_cselect_b64 s[72:73], -1, 0
v_cndmask_b32 v36, v36, v15, s[72:73]
s_cmp_eq_u32 s76, 5
s_cselect_b64 s[72:73], -1, 0
v_cndmask_b32 v37, v37, v15, s[72:73]
s_cmp_eq_u32 s71, 6
s_cselect_b64 s[72:73], -1, 0
v_cndmask_b32 v36, v36, v16, s[72:73]
s_cmp_eq_u32 s76, 6
s_cselect_b64 s[72:73], -1, 0
v_cndmask_b32 v37, v37, v16, s[72:73]
s_nop 0
s_nop 0
v_add_f32_dpp v2, v2, v2 quad_perm:[1,0,3,2] row_mask:0xf bank_mask:0xf
v_add_f32_dpp v3, v3, v3 quad_perm:[1,0,3,2] row_mask:0xf bank_mask:0xf
s_nop 0
v_add_f32_dpp v2, v2, v2 quad_perm:[2,3,0,1] row_mask:0xf bank_mask:0xf
v_add_f32_dpp v3, v3, v3 quad_perm:[2,3,0,1] row_mask:0xf bank_mask:0xf
s_nop 0
v_add_f32_dpp v2, v2, v2 row_half_mirror row_mask:0xf bank_mask:0xf
v_add_f32_dpp v3, v3, v3 row_half_mirror row_mask:0xf bank_mask:0xf
s_nop 0
v_add_f32_dpp v2, v2, v2 row_mirror row_mask:0xf bank_mask:0xf
v_add_f32_dpp v3, v3, v3 row_mirror row_mask:0xf bank_mask:0xf
v_mov_b32 v4, v2
v_mov_b32 v5, v2
v_mov_b32 v6, v3
v_mov_b32 v7, v3
v_permlane16_swap_b32 v4, v5
s_nop 0
v_permlane16_swap_b32 v6, v7
s_nop 0
v_add_f32 v2, v4, v5
v_add_f32 v3, v6, v7
v_mov_b32 v4, v2
v_mov_b32 v5, v2
v_mov_b32 v6, v3
v_mov_b32 v7, v3
v_permlane32_swap_b32 v4, v5
s_nop 0
v_permlane32_swap_b32 v6, v7
s_nop 0
v_add_f32 v2, v4, v5
v_add_f32 v3, v6, v7
v_readlane_b32 s40, v36, s70
v_readlane_b32 s41, v37, s75
v_mul_f32 v5, 0x3b124925, v2
v_mul_f32 v2, 0x3b124925, v3
v_fma_f32 v2, -v5, v5, v2
v_max_f32 v2, 0, v2
v_mov_b32 v36, s40
v_mov_b32 v37, s41
v_cvt_pk_bf16_f32 v3, v5, v2
v_lshlrev_b32 v5, 16, v3
v_and_b32 v2, 0xffff0000, v3
v_add_f32 v2, 0x3727c5ac, v2
v_cvt_pk_bf16_f32 v3, v2, v2
v_lshlrev_b32 v2, 16, v3
v_sqrt_f32 v2, v2
s_nop 0
v_cvt_pk_bf16_f32 v3, v2, v2
v_lshlrev_b32 v2, 16, v3
v_rcp_f32 v7, v2
s_nop 0
v_sub_f32 v36, v36, v5
v_sub_f32 v37, v37, v5
v_cvt_pk_bf16_f32 v3, v36, v37
v_lshlrev_b32 v36, 16, v3
v_and_b32 v37, 0xffff0000, v3
v_mul_f32 v36, v36, v7
v_mul_f32 v37, v37, v7
v_cvt_pk_bf16_f32 v3, v36, v37
v_lshlrev_b32 v36, 16, v3
v_and_b32 v37, 0xffff0000, v3
s_mov_b32 s42, 0xc0135761
s_mov_b32 s43, 0xbdd2d3e8
v_mov_b32 v40, 0
v_mov_b32 v41, 0
v_mov_b32 v42, s42
v_mov_b32 v38, s43
v_pk_fma_f32 v[44:45], v[36:37], v[128:129], v[156:157] op_sel:[0,0,0] op_sel_hi:[1,0,0]
v_pk_mul_f32 v[46:47], v[44:45], v[44:45]
v_pk_fma_f32 v[48:49], v[36:37], v[128:129], v[156:157] op_sel:[0,1,1] op_sel_hi:[1,1,1]
v_pk_mul_f32 v[50:51], v[48:49], v[48:49]
v_pk_fma_f32 v[46:47], v[46:47], v[38:39], v[42:43] op_sel:[0,0,0] op_sel_hi:[1,0,0]
v_pk_mul_f32 v[46:47], v[46:47], v[44:45]
v_pk_fma_f32 v[50:51], v[50:51], v[38:39], v[42:43] op_sel:[0,0,0] op_sel_hi:[1,0,0]
v_pk_mul_f32 v[50:51], v[50:51], v[48:49]
v_exp_f32 v46, v46
v_exp_f32 v47, v47
v_exp_f32 v50, v50
v_exp_f32 v51, v51
v_pk_mul_f32 v[44:45], v[44:45], v[184:185] op_sel:[0,0] op_sel_hi:[1,0]
v_pk_add_f32 v[46:47], v[46:47], 1.0 op_sel_hi:[1,0]
v_pk_mul_f32 v[48:49], v[48:49], v[184:185] op_sel:[0,1] op_sel_hi:[1,1]
v_pk_add_f32 v[50:51], v[50:51], 1.0 op_sel_hi:[1,0]
v_rcp_f32 v46, v46
v_rcp_f32 v47, v47
v_rcp_f32 v50, v50
v_rcp_f32 v51, v51
s_nop 0
v_pk_fma_f32 v[40:41], v[44:45], v[46:47], v[40:41]
v_pk_fma_f32 v[40:41], v[48:49], v[50:51], v[40:41]
v_pk_fma_f32 v[44:45], v[36:37], v[130:131], v[158:159] op_sel:[0,0,0] op_sel_hi:[1,0,0]
v_pk_mul_f32 v[46:47], v[44:45], v[44:45]
v_pk_fma_f32 v[48:49], v[36:37], v[130:131], v[158:159] op_sel:[0,1,1] op_sel_hi:[1,1,1]
v_pk_mul_f32 v[50:51], v[48:49], v[48:49]
v_pk_fma_f32 v[46:47], v[46:47], v[38:39], v[42:43] op_sel:[0,0,0] op_sel_hi:[1,0,0]
v_pk_mul_f32 v[46:47], v[46:47], v[44:45]
v_pk_fma_f32 v[50:51], v[50:51], v[38:39], v[42:43] op_sel:[0,0,0] op_sel_hi:[1,0,0]
v_pk_mul_f32 v[50:51], v[50:51], v[48:49]
v_exp_f32 v46, v46
v_exp_f32 v47, v47
v_exp_f32 v50, v50
v_exp_f32 v51, v51
v_pk_mul_f32 v[44:45], v[44:45], v[186:187] op_sel:[0,0] op_sel_hi:[1,0]
v_pk_add_f32 v[46:47], v[46:47], 1.0 op_sel_hi:[1,0]
v_pk_mul_f32 v[48:49], v[48:49], v[186:187] op_sel:[0,1] op_sel_hi:[1,1]
v_pk_add_f32 v[50:51], v[50:51], 1.0 op_sel_hi:[1,0]
v_rcp_f32 v46, v46
v_rcp_f32 v47, v47
v_rcp_f32 v50, v50
v_rcp_f32 v51, v51
s_nop 0
v_pk_fma_f32 v[40:41], v[44:45], v[46:47], v[40:41]
v_pk_fma_f32 v[40:41], v[48:49], v[50:51], v[40:41]
v_pk_fma_f32 v[44:45], v[36:37], v[132:133], v[160:161] op_sel:[0,0,0] op_sel_hi:[1,0,0]
v_pk_mul_f32 v[46:47], v[44:45], v[44:45]
v_pk_fma_f32 v[48:49], v[36:37], v[132:133], v[160:161] op_sel:[0,1,1] op_sel_hi:[1,1,1]
v_pk_mul_f32 v[50:51], v[48:49], v[48:49]
v_pk_fma_f32 v[46:47], v[46:47], v[38:39], v[42:43] op_sel:[0,0,0] op_sel_hi:[1,0,0]
v_pk_mul_f32 v[46:47], v[46:47], v[44:45]
v_pk_fma_f32 v[50:51], v[50:51], v[38:39], v[42:43] op_sel:[0,0,0] op_sel_hi:[1,0,0]
v_pk_mul_f32 v[50:51], v[50:51], v[48:49]
v_exp_f32 v46, v46
v_exp_f32 v47, v47
v_exp_f32 v50, v50
v_exp_f32 v51, v51
v_pk_mul_f32 v[44:45], v[44:45], v[188:189] op_sel:[0,0] op_sel_hi:[1,0]
v_pk_add_f32 v[46:47], v[46:47], 1.0 op_sel_hi:[1,0]
v_pk_mul_f32 v[48:49], v[48:49], v[188:189] op_sel:[0,1] op_sel_hi:[1,1]
v_pk_add_f32 v[50:51], v[50:51], 1.0 op_sel_hi:[1,0]
v_rcp_f32 v46, v46
v_rcp_f32 v47, v47
v_rcp_f32 v50, v50
v_rcp_f32 v51, v51
s_nop 0
v_pk_fma_f32 v[40:41], v[44:45], v[46:47], v[40:41]
v_pk_fma_f32 v[40:41], v[48:49], v[50:51], v[40:41]
v_pk_fma_f32 v[44:45], v[36:37], v[134:135], v[162:163] op_sel:[0,0,0] op_sel_hi:[1,0,0]
v_pk_mul_f32 v[46:47], v[44:45], v[44:45]
v_pk_fma_f32 v[48:49], v[36:37], v[134:135], v[162:163] op_sel:[0,1,1] op_sel_hi:[1,1,1]
v_pk_mul_f32 v[50:51], v[48:49], v[48:49]
v_pk_fma_f32 v[46:47], v[46:47], v[38:39], v[42:43] op_sel:[0,0,0] op_sel_hi:[1,0,0]
v_pk_mul_f32 v[46:47], v[46:47], v[44:45]
v_pk_fma_f32 v[50:51], v[50:51], v[38:39], v[42:43] op_sel:[0,0,0] op_sel_hi:[1,0,0]
v_pk_mul_f32 v[50:51], v[50:51], v[48:49]
v_exp_f32 v46, v46
v_exp_f32 v47, v47
v_exp_f32 v50, v50
v_exp_f32 v51, v51
v_pk_mul_f32 v[44:45], v[44:45], v[190:191] op_sel:[0,0] op_sel_hi:[1,0]
v_pk_add_f32 v[46:47], v[46:47], 1.0 op_sel_hi:[1,0]
v_pk_mul_f32 v[48:49], v[48:49], v[190:191] op_sel:[0,1] op_sel_hi:[1,1]
v_pk_add_f32 v[50:51], v[50:51], 1.0 op_sel_hi:[1,0]
v_rcp_f32 v46, v46
v_rcp_f32 v47, v47
v_rcp_f32 v50, v50
v_rcp_f32 v51, v51
s_nop 0
v_pk_fma_f32 v[40:41], v[44:45], v[46:47], v[40:41]
v_pk_fma_f32 v[40:41], v[48:49], v[50:51], v[40:41]
v_pk_fma_f32 v[44:45], v[36:37], v[136:137], v[164:165] op_sel:[0,0,0] op_sel_hi:[1,0,0]
v_pk_mul_f32 v[46:47], v[44:45], v[44:45]
v_pk_fma_f32 v[48:49], v[36:37], v[136:137], v[164:165] op_sel:[0,1,1] op_sel_hi:[1,1,1]
v_pk_mul_f32 v[50:51], v[48:49], v[48:49]
v_pk_fma_f32 v[46:47], v[46:47], v[38:39], v[42:43] op_sel:[0,0,0] op_sel_hi:[1,0,0]
v_pk_mul_f32 v[46:47], v[46:47], v[44:45]
v_pk_fma_f32 v[50:51], v[50:51], v[38:39], v[42:43] op_sel:[0,0,0] op_sel_hi:[1,0,0]
v_pk_mul_f32 v[50:51], v[50:51], v[48:49]
v_exp_f32 v46, v46
v_exp_f32 v47, v47
v_exp_f32 v50, v50
v_exp_f32 v51, v51
v_pk_mul_f32 v[44:45], v[44:45], v[192:193] op_sel:[0,0] op_sel_hi:[1,0]
v_pk_add_f32 v[46:47], v[46:47], 1.0 op_sel_hi:[1,0]
v_pk_mul_f32 v[48:49], v[48:49], v[192:193] op_sel:[0,1] op_sel_hi:[1,1]
v_pk_add_f32 v[50:51], v[50:51], 1.0 op_sel_hi:[1,0]
v_rcp_f32 v46, v46
v_rcp_f32 v47, v47
v_rcp_f32 v50, v50
v_rcp_f32 v51, v51
s_nop 0
v_pk_fma_f32 v[40:41], v[44:45], v[46:47], v[40:41]
v_pk_fma_f32 v[40:41], v[48:49], v[50:51], v[40:41]
v_pk_fma_f32 v[44:45], v[36:37], v[138:139], v[166:167] op_sel:[0,0,0] op_sel_hi:[1,0,0]
v_pk_mul_f32 v[46:47], v[44:45], v[44:45]
v_pk_fma_f32 v[48:49], v[36:37], v[138:139], v[166:167] op_sel:[0,1,1] op_sel_hi:[1,1,1]
v_pk_mul_f32 v[50:51], v[48:49], v[48:49]
v_pk_fma_f32 v[46:47], v[46:47], v[38:39], v[42:43] op_sel:[0,0,0] op_sel_hi:[1,0,0]
v_pk_mul_f32 v[46:47], v[46:47], v[44:45]
v_pk_fma_f32 v[50:51], v[50:51], v[38:39], v[42:43] op_sel:[0,0,0] op_sel_hi:[1,0,0]
v_pk_mul_f32 v[50:51], v[50:51], v[48:49]
v_exp_f32 v46, v46
v_exp_f32 v47, v47
v_exp_f32 v50, v50
v_exp_f32 v51, v51
v_pk_mul_f32 v[44:45], v[44:45], v[194:195] op_sel:[0,0] op_sel_hi:[1,0]
v_pk_add_f32 v[46:47], v[46:47], 1.0 op_sel_hi:[1,0]
v_pk_mul_f32 v[48:49], v[48:49], v[194:195] op_sel:[0,1] op_sel_hi:[1,1]
v_pk_add_f32 v[50:51], v[50:51], 1.0 op_sel_hi:[1,0]
v_rcp_f32 v46, v46
v_rcp_f32 v47, v47
v_rcp_f32 v50, v50
v_rcp_f32 v51, v51
s_nop 0
v_pk_fma_f32 v[40:41], v[44:45], v[46:47], v[40:41]
v_pk_fma_f32 v[40:41], v[48:49], v[50:51], v[40:41]
v_pk_fma_f32 v[44:45], v[36:37], v[140:141], v[168:169] op_sel:[0,0,0] op_sel_hi:[1,0,0]
v_pk_mul_f32 v[46:47], v[44:45], v[44:45]
v_pk_fma_f32 v[48:49], v[36:37], v[140:141], v[168:169] op_sel:[0,1,1] op_sel_hi:[1,1,1]
v_pk_mul_f32 v[50:51], v[48:49], v[48:49]
v_pk_fma_f32 v[46:47], v[46:47], v[38:39], v[42:43] op_sel:[0,0,0] op_sel_hi:[1,0,0]
v_pk_mul_f32 v[46:47], v[46:47], v[44:45]
v_pk_fma_f32 v[50:51], v[50:51], v[38:39], v[42:43] op_sel:[0,0,0] op_sel_hi:[1,0,0]
v_pk_mul_f32 v[50:51], v[50:51], v[48:49]
v_exp_f32 v46, v46
v_exp_f32 v47, v47
v_exp_f32 v50, v50
v_exp_f32 v51, v51
v_pk_mul_f32 v[44:45], v[44:45], v[196:197] op_sel:[0,0] op_sel_hi:[1,0]
v_pk_add_f32 v[46:47], v[46:47], 1.0 op_sel_hi:[1,0]
v_pk_mul_f32 v[48:49], v[48:49], v[196:197] op_sel:[0,1] op_sel_hi:[1,1]
v_pk_add_f32 v[50:51], v[50:51], 1.0 op_sel_hi:[1,0]
v_rcp_f32 v46, v46
v_rcp_f32 v47, v47
v_rcp_f32 v50, v50
v_rcp_f32 v51, v51
s_nop 0
v_pk_fma_f32 v[40:41], v[44:45], v[46:47], v[40:41]
v_pk_fma_f32 v[40:41], v[48:49], v[50:51], v[40:41]
v_pk_fma_f32 v[44:45], v[36:37], v[142:143], v[170:171] op_sel:[0,0,0] op_sel_hi:[1,0,0]
v_pk_mul_f32 v[46:47], v[44:45], v[44:45]
v_pk_fma_f32 v[48:49], v[36:37], v[142:143], v[170:171] op_sel:[0,1,1] op_sel_hi:[1,1,1]
v_pk_mul_f32 v[50:51], v[48:49], v[48:49]
v_pk_fma_f32 v[46:47], v[46:47], v[38:39], v[42:43] op_sel:[0,0,0] op_sel_hi:[1,0,0]
v_pk_mul_f32 v[46:47], v[46:47], v[44:45]
v_pk_fma_f32 v[50:51], v[50:51], v[38:39], v[42:43] op_sel:[0,0,0] op_sel_hi:[1,0,0]
v_pk_mul_f32 v[50:51], v[50:51], v[48:49]
v_exp_f32 v46, v46
v_exp_f32 v47, v47
v_exp_f32 v50, v50
v_exp_f32 v51, v51
v_pk_mul_f32 v[44:45], v[44:45], v[198:199] op_sel:[0,0] op_sel_hi:[1,0]
v_pk_add_f32 v[46:47], v[46:47], 1.0 op_sel_hi:[1,0]
v_pk_mul_f32 v[48:49], v[48:49], v[198:199] op_sel:[0,1] op_sel_hi:[1,1]
v_pk_add_f32 v[50:51], v[50:51], 1.0 op_sel_hi:[1,0]
v_rcp_f32 v46, v46
v_rcp_f32 v47, v47
v_rcp_f32 v50, v50
v_rcp_f32 v51, v51
s_nop 0
v_pk_fma_f32 v[40:41], v[44:45], v[46:47], v[40:41]
v_pk_fma_f32 v[40:41], v[48:49], v[50:51], v[40:41]
v_pk_fma_f32 v[44:45], v[36:37], v[144:145], v[172:173] op_sel:[0,0,0] op_sel_hi:[1,0,0]
v_pk_mul_f32 v[46:47], v[44:45], v[44:45]
v_pk_fma_f32 v[48:49], v[36:37], v[144:145], v[172:173] op_sel:[0,1,1] op_sel_hi:[1,1,1]
v_pk_mul_f32 v[50:51], v[48:49], v[48:49]
v_pk_fma_f32 v[46:47], v[46:47], v[38:39], v[42:43] op_sel:[0,0,0] op_sel_hi:[1,0,0]
v_pk_mul_f32 v[46:47], v[46:47], v[44:45]
v_pk_fma_f32 v[50:51], v[50:51], v[38:39], v[42:43] op_sel:[0,0,0] op_sel_hi:[1,0,0]
v_pk_mul_f32 v[50:51], v[50:51], v[48:49]
v_exp_f32 v46, v46
v_exp_f32 v47, v47
v_exp_f32 v50, v50
v_exp_f32 v51, v51
v_pk_mul_f32 v[44:45], v[44:45], v[200:201] op_sel:[0,0] op_sel_hi:[1,0]
v_pk_add_f32 v[46:47], v[46:47], 1.0 op_sel_hi:[1,0]
v_pk_mul_f32 v[48:49], v[48:49], v[200:201] op_sel:[0,1] op_sel_hi:[1,1]
v_pk_add_f32 v[50:51], v[50:51], 1.0 op_sel_hi:[1,0]
v_rcp_f32 v46, v46
v_rcp_f32 v47, v47
v_rcp_f32 v50, v50
v_rcp_f32 v51, v51
s_nop 0
v_pk_fma_f32 v[40:41], v[44:45], v[46:47], v[40:41]
v_pk_fma_f32 v[40:41], v[48:49], v[50:51], v[40:41]
v_pk_fma_f32 v[44:45], v[36:37], v[146:147], v[174:175] op_sel:[0,0,0] op_sel_hi:[1,0,0]
v_pk_mul_f32 v[46:47], v[44:45], v[44:45]
v_pk_fma_f32 v[48:49], v[36:37], v[146:147], v[174:175] op_sel:[0,1,1] op_sel_hi:[1,1,1]
v_pk_mul_f32 v[50:51], v[48:49], v[48:49]
v_pk_fma_f32 v[46:47], v[46:47], v[38:39], v[42:43] op_sel:[0,0,0] op_sel_hi:[1,0,0]
v_pk_mul_f32 v[46:47], v[46:47], v[44:45]
v_pk_fma_f32 v[50:51], v[50:51], v[38:39], v[42:43] op_sel:[0,0,0] op_sel_hi:[1,0,0]
v_pk_mul_f32 v[50:51], v[50:51], v[48:49]
v_exp_f32 v46, v46
v_exp_f32 v47, v47
v_exp_f32 v50, v50
v_exp_f32 v51, v51
v_pk_mul_f32 v[44:45], v[44:45], v[202:203] op_sel:[0,0] op_sel_hi:[1,0]
v_pk_add_f32 v[46:47], v[46:47], 1.0 op_sel_hi:[1,0]
v_pk_mul_f32 v[48:49], v[48:49], v[202:203] op_sel:[0,1] op_sel_hi:[1,1]
v_pk_add_f32 v[50:51], v[50:51], 1.0 op_sel_hi:[1,0]
v_rcp_f32 v46, v46
v_rcp_f32 v47, v47
v_rcp_f32 v50, v50
v_rcp_f32 v51, v51
s_nop 0
v_pk_fma_f32 v[40:41], v[44:45], v[46:47], v[40:41]
v_pk_fma_f32 v[40:41], v[48:49], v[50:51], v[40:41]
v_pk_fma_f32 v[44:45], v[36:37], v[148:149], v[176:177] op_sel:[0,0,0] op_sel_hi:[1,0,0]
v_pk_mul_f32 v[46:47], v[44:45], v[44:45]
v_pk_fma_f32 v[48:49], v[36:37], v[148:149], v[176:177] op_sel:[0,1,1] op_sel_hi:[1,1,1]
v_pk_mul_f32 v[50:51], v[48:49], v[48:49]
v_pk_fma_f32 v[46:47], v[46:47], v[38:39], v[42:43] op_sel:[0,0,0] op_sel_hi:[1,0,0]
v_pk_mul_f32 v[46:47], v[46:47], v[44:45]
v_pk_fma_f32 v[50:51], v[50:51], v[38:39], v[42:43] op_sel:[0,0,0] op_sel_hi:[1,0,0]
v_pk_mul_f32 v[50:51], v[50:51], v[48:49]
v_exp_f32 v46, v46
v_exp_f32 v47, v47
v_exp_f32 v50, v50
v_exp_f32 v51, v51
v_pk_mul_f32 v[44:45], v[44:45], v[204:205] op_sel:[0,0] op_sel_hi:[1,0]
v_pk_add_f32 v[46:47], v[46:47], 1.0 op_sel_hi:[1,0]
v_pk_mul_f32 v[48:49], v[48:49], v[204:205] op_sel:[0,1] op_sel_hi:[1,1]
v_pk_add_f32 v[50:51], v[50:51], 1.0 op_sel_hi:[1,0]
v_rcp_f32 v46, v46
v_rcp_f32 v47, v47
v_rcp_f32 v50, v50
v_rcp_f32 v51, v51
s_nop 0
v_pk_fma_f32 v[40:41], v[44:45], v[46:47], v[40:41]
v_pk_fma_f32 v[40:41], v[48:49], v[50:51], v[40:41]
v_pk_fma_f32 v[44:45], v[36:37], v[150:151], v[178:179] op_sel:[0,0,0] op_sel_hi:[1,0,0]
v_pk_mul_f32 v[46:47], v[44:45], v[44:45]
v_pk_fma_f32 v[48:49], v[36:37], v[150:151], v[178:179] op_sel:[0,1,1] op_sel_hi:[1,1,1]
v_pk_mul_f32 v[50:51], v[48:49], v[48:49]
v_pk_fma_f32 v[46:47], v[46:47], v[38:39], v[42:43] op_sel:[0,0,0] op_sel_hi:[1,0,0]
v_pk_mul_f32 v[46:47], v[46:47], v[44:45]
v_pk_fma_f32 v[50:51], v[50:51], v[38:39], v[42:43] op_sel:[0,0,0] op_sel_hi:[1,0,0]
v_pk_mul_f32 v[50:51], v[50:51], v[48:49]
v_exp_f32 v46, v46
v_exp_f32 v47, v47
v_exp_f32 v50, v50
v_exp_f32 v51, v51
v_pk_mul_f32 v[44:45], v[44:45], v[206:207] op_sel:[0,0] op_sel_hi:[1,0]
v_pk_add_f32 v[46:47], v[46:47], 1.0 op_sel_hi:[1,0]
v_pk_mul_f32 v[48:49], v[48:49], v[206:207] op_sel:[0,1] op_sel_hi:[1,1]
v_pk_add_f32 v[50:51], v[50:51], 1.0 op_sel_hi:[1,0]
v_rcp_f32 v46, v46
v_rcp_f32 v47, v47
v_rcp_f32 v50, v50
v_rcp_f32 v51, v51
s_nop 0
v_pk_fma_f32 v[40:41], v[44:45], v[46:47], v[40:41]
v_pk_fma_f32 v[40:41], v[48:49], v[50:51], v[40:41]
v_pk_fma_f32 v[44:45], v[36:37], v[152:153], v[180:181] op_sel:[0,0,0] op_sel_hi:[1,0,0]
v_pk_mul_f32 v[46:47], v[44:45], v[44:45]
v_pk_fma_f32 v[48:49], v[36:37], v[152:153], v[180:181] op_sel:[0,1,1] op_sel_hi:[1,1,1]
v_pk_mul_f32 v[50:51], v[48:49], v[48:49]
v_pk_fma_f32 v[46:47], v[46:47], v[38:39], v[42:43] op_sel:[0,0,0] op_sel_hi:[1,0,0]
v_pk_mul_f32 v[46:47], v[46:47], v[44:45]
v_pk_fma_f32 v[50:51], v[50:51], v[38:39], v[42:43] op_sel:[0,0,0] op_sel_hi:[1,0,0]
v_pk_mul_f32 v[50:51], v[50:51], v[48:49]
v_exp_f32 v46, v46
v_exp_f32 v47, v47
v_exp_f32 v50, v50
v_exp_f32 v51, v51
v_pk_mul_f32 v[44:45], v[44:45], v[208:209] op_sel:[0,0] op_sel_hi:[1,0]
v_pk_add_f32 v[46:47], v[46:47], 1.0 op_sel_hi:[1,0]
v_pk_mul_f32 v[48:49], v[48:49], v[208:209] op_sel:[0,1] op_sel_hi:[1,1]
v_pk_add_f32 v[50:51], v[50:51], 1.0 op_sel_hi:[1,0]
v_rcp_f32 v46, v46
v_rcp_f32 v47, v47
v_rcp_f32 v50, v50
v_rcp_f32 v51, v51
s_nop 0
v_pk_fma_f32 v[40:41], v[44:45], v[46:47], v[40:41]
v_pk_fma_f32 v[40:41], v[48:49], v[50:51], v[40:41]
v_pk_fma_f32 v[44:45], v[36:37], v[154:155], v[182:183] op_sel:[0,0,0] op_sel_hi:[1,0,0]
v_pk_mul_f32 v[46:47], v[44:45], v[44:45]
v_pk_fma_f32 v[48:49], v[36:37], v[154:155], v[182:183] op_sel:[0,1,1] op_sel_hi:[1,1,1]
v_pk_mul_f32 v[50:51], v[48:49], v[48:49]
v_pk_fma_f32 v[46:47], v[46:47], v[38:39], v[42:43] op_sel:[0,0,0] op_sel_hi:[1,0,0]
v_pk_mul_f32 v[46:47], v[46:47], v[44:45]
v_pk_fma_f32 v[50:51], v[50:51], v[38:39], v[42:43] op_sel:[0,0,0] op_sel_hi:[1,0,0]
v_pk_mul_f32 v[50:51], v[50:51], v[48:49]
v_exp_f32 v46, v46
v_exp_f32 v47, v47
v_exp_f32 v50, v50
v_exp_f32 v51, v51
v_pk_mul_f32 v[44:45], v[44:45], v[210:211] op_sel:[0,0] op_sel_hi:[1,0]
v_pk_add_f32 v[46:47], v[46:47], 1.0 op_sel_hi:[1,0]
v_pk_mul_f32 v[48:49], v[48:49], v[210:211] op_sel:[0,1] op_sel_hi:[1,1]
v_pk_add_f32 v[50:51], v[50:51], 1.0 op_sel_hi:[1,0]
v_rcp_f32 v46, v46
v_rcp_f32 v47, v47
v_rcp_f32 v50, v50
v_rcp_f32 v51, v51
s_nop 0
v_pk_fma_f32 v[40:41], v[44:45], v[46:47], v[40:41]
v_pk_fma_f32 v[40:41], v[48:49], v[50:51], v[40:41]
s_nop 0
s_nop 0
v_add_f32_dpp v40, v40, v40 quad_perm:[1,0,3,2] row_mask:0xf bank_mask:0xf
v_add_f32_dpp v41, v41, v41 quad_perm:[1,0,3,2] row_mask:0xf bank_mask:0xf
s_nop 0
v_add_f32_dpp v40, v40, v40 quad_perm:[2,3,0,1] row_mask:0xf bank_mask:0xf
v_add_f32_dpp v41, v41, v41 quad_perm:[2,3,0,1] row_mask:0xf bank_mask:0xf
s_nop 0
v_add_f32_dpp v40, v40, v40 row_half_mirror row_mask:0xf bank_mask:0xf
v_add_f32_dpp v41, v41, v41 row_half_mirror row_mask:0xf bank_mask:0xf
s_nop 0
v_add_f32_dpp v40, v40, v40 row_mirror row_mask:0xf bank_mask:0xf
v_add_f32_dpp v41, v41, v41 row_mirror row_mask:0xf bank_mask:0xf
v_mov_b32 v44, v40
v_mov_b32 v45, v40
v_mov_b32 v46, v41
v_mov_b32 v47, v41
v_permlane16_swap_b32 v44, v45
s_nop 0
v_permlane16_swap_b32 v46, v47
s_nop 0
v_add_f32 v40, v44, v45
v_add_f32 v41, v46, v47
v_mov_b32 v44, v40
v_mov_b32 v45, v40
v_mov_b32 v46, v41
v_mov_b32 v47, v41
v_permlane32_swap_b32 v44, v45
s_nop 0
v_permlane32_swap_b32 v46, v47
s_nop 0
v_add_f32 v40, v44, v45
v_add_f32 v41, v46, v47
v_lshlrev_b32 v75, 16, v75
v_cvt_pk_bf16_f32 v44, v40, v41
v_lshlrev_b32 v40, 16, v44
v_and_b32 v41, 0xffff0000, v44
v_add_f32 v40, v40, v75
v_add_f32 v41, v41, v75
v_cvt_pk_bf16_f32 v44, v40, v41
v_lshlrev_b32 v40, 16, v44
v_and_b32 v41, 0xffff0000, v44
v_add_f32 v40, v40, v34
v_add_f32 v41, v41, v35
v_cvt_pk_bf16_f32 v40, v40, v41
s_mov_b32 s56, s24
s_and_b32 s57, s25, 0xffff
s_mov_b32 s58, 7168
s_mov_b32 s59, 0x00020000
s_mul_i32 s70, s61, 448
s_add_u32 s70, s70, s69
s_lshl_b32 s70, s70, 1
v_mov_b32 v7, 0
v_cmp_eq_u32 vcc, 0, v1
s_and_saveexec_b64 s[72:73], vcc
buffer_store_dword v40, v7, s[56:59], s70 offen
L_END:
s_endpgm
.section .rodata,"a"
.p2align 6
.amdhsa_kernel sequential_preLN__gqa_block_cached__mixer_token_mlp__decode_kernel
  .amdhsa_next_free_vgpr 256
  .amdhsa_next_free_sgpr 102
  .amdhsa_accum_offset 256
  .amdhsa_group_segment_fixed_size 0
  .amdhsa_kernarg_size 104
  .amdhsa_user_sgpr_count 2
  .amdhsa_user_sgpr_kernarg_segment_ptr 1
  .amdhsa_system_sgpr_workgroup_id_x 1
.end_amdhsa_kernel
```
